```python
import torch

def _softmax(x, axis=-1):
    return torch.softmax(x, dim=axis)
def _gelu(x):
    return torch.nn.functional.gelu(x, approximate="tanh")
def _silu(x):
    return torch.nn.functional.silu(x)
def _sigmoid(x):
    return torch.sigmoid(x)
def _layernorm(x, axis=-1, eps=1e-5):
    m = x.mean(dim=axis, keepdim=True)
    v = x.var(dim=axis, keepdim=True, unbiased=False)
    return (x - m) / torch.sqrt(v + eps)
def _scatter_add(tgt, idx, src, axis=0):
    return tgt.clone().index_add_(axis, idx, src)
def _segment_sum(src, seg, n):
    out = torch.zeros((n,) + src.shape[1:], dtype=src.dtype)
    return out.index_add_(0, seg, src)
def _pad(x, pw):
    flat = tuple(v for pair in reversed(pw) for v in pair)
    return torch.nn.functional.pad(x, flat)

kernel_name = 'concat_heads__ssm_conv_s4__ssm_conv_s5__prompt'

def setup_inputs():

    _w = (lambda a: (lambda t: t.to(torch.bfloat16) if t.is_floating_point() else t)(torch.as_tensor(a)))
    def _A_setup():
        B, L, D, N = 1, 2048, 576, 128
        A_re = -(lambda _x: torch.exp(torch.as_tensor(_x)))((lambda *s: torch.randn(*s, dtype=torch.bfloat16) * 3.2)(D, N))
        A_im = torch.pi * (lambda *s: torch.randn(*s, dtype=torch.bfloat16) * 0.05)(D, N)
        B_re = (lambda *s: torch.randn(*s, dtype=torch.bfloat16) * 0.1)(D, N)
        B_im = (lambda *s: torch.randn(*s, dtype=torch.bfloat16) * 0.1)(D, N)
        C_re = (lambda *s: torch.randn(*s, dtype=torch.bfloat16) * 0.1)(D, N)
        C_im = (lambda *s: torch.randn(*s, dtype=torch.bfloat16) * 0.1)(D, N)
        log_dt = (lambda *s: torch.randn(*s, dtype=torch.bfloat16) * 0.05)(D) * 0.5 - 4.0
        Dskip = (lambda *s: torch.randn(*s, dtype=torch.bfloat16) * 0.05)(D)
        return {
            "u": _w((lambda *s: torch.randn(*s, dtype=torch.bfloat16) * 0.05)(B, L, D)),
            "A_re": _w(A_re),
            "A_im": _w(A_im),
            "B_re": _w(B_re),
            "B_im": _w(B_im),
            "C_re": _w(C_re),
            "C_im": _w(C_im),
            "log_dt": _w(log_dt),
            "Dskip": _w(Dskip),
        }
    _A_in = _A_setup()

    def _B_setup():
        B, S, D = 1, 2048, 576
        P = D
        Lambda_re = -0.5 * (lambda _x: torch.exp(torch.as_tensor(_x)))((lambda *s: torch.randn(*s, dtype=torch.bfloat16) * 0.2)(P))
        Lambda_im = (lambda *s: torch.randn(*s, dtype=torch.bfloat16) * 0.4)(P) * 1.0
        B_re = (lambda *s: torch.randn(*s, dtype=torch.bfloat16) * 0.2)(P, D) * (D ** -0.5)
        B_im = (lambda *s: torch.randn(*s, dtype=torch.bfloat16) * 0.2)(P, D) * (D ** -0.5)
        C_re = (lambda *s: torch.randn(*s, dtype=torch.bfloat16) * 0.2)(D, P) * (P ** -0.5)
        C_im = (lambda *s: torch.randn(*s, dtype=torch.bfloat16) * 0.2)(D, P) * (P ** -0.5)
        log_dt = (lambda *s: torch.randn(*s, dtype=torch.bfloat16) * 0.2)(P) * 0.3 - 2.0
        Dskip = (lambda *s: torch.randn(*s, dtype=torch.bfloat16) * 0.05)(D)
        return {
            "x": _w((lambda *s: torch.randn(*s, dtype=torch.bfloat16) * 0.05)(B, S, D)),
            "Lambda_re": _w(Lambda_re),
            "Lambda_im": _w(Lambda_im),
            "B_re": _w(B_re),
            "B_im": _w(B_im),
            "C_re": _w(C_re),
            "C_im": _w(C_im),
            "log_dt": _w(log_dt),
            "Dskip": _w(Dskip),
        }
    _B_in = _B_setup()

    return {
        "A_u": _A_in["u"],
        "A_A_re": _A_in["A_re"],
        "A_A_im": _A_in["A_im"],
        "A_B_re": _A_in["B_re"],
        "A_B_im": _A_in["B_im"],
        "A_C_re": _A_in["C_re"],
        "A_C_im": _A_in["C_im"],
        "A_log_dt": _A_in["log_dt"],
        "A_Dskip": _A_in["Dskip"],
        "B_x": _B_in["x"],
        "B_Lambda_re": _B_in["Lambda_re"],
        "B_Lambda_im": _B_in["Lambda_im"],
        "B_B_re": _B_in["B_re"],
        "B_B_im": _B_in["B_im"],
        "B_C_re": _B_in["C_re"],
        "B_C_im": _B_in["C_im"],
        "B_log_dt": _B_in["log_dt"],
        "B_Dskip": _B_in["Dskip"],
    }

def reference(A_u, A_A_re, A_A_im, A_B_re, A_B_im, A_C_re, A_C_im, A_log_dt, A_Dskip, B_x, B_Lambda_re, B_Lambda_im, B_B_re, B_B_im, B_C_re, B_C_im, B_log_dt, B_Dskip):
    def _A_ref(u, A_re, A_im, B_re, B_im, C_re, C_im, log_dt, Dskip):
        Bsz, L, D = u.shape
        dt = torch.exp(log_dt)[:, None]
        A = A_re + 1j * A_im
        Bc = B_re + 1j * B_im
        Cc = C_re + 1j * C_im
        logdA = dt * A
        dB = dt * Bc
        l = (lambda x, dt: x.to(dt))(torch.arange(L), A_re.dtype)
        P = torch.exp(logdA[:, :, None] * l[None, None, :])
        K = torch.einsum("dn,dnl,dn->dl", Cc, P, dB).real
        L2 = 2 * L
        Kp = _pad(K, ((0, 0), (0, L)))
        up = (lambda x, *d: x.permute(*d))(u, 0, 2, 1)
        up = _pad(up, ((0, 0), (0, 0), (0, L)))
        Kf = (lambda x, axes=(-2,-1): torch.fft.rfft2(x.float(), dim=axes))(Kp[:, None, :], axes=(-2, -1))
        Uf = (lambda x, axes=(-2,-1): torch.fft.rfft2(x.float(), dim=axes))(up[:, :, None, :], axes=(-2, -1))
        Yf = Uf * Kf[None, :, :, :]
        y = (lambda x, s, axes=(-2,-1): torch.fft.irfft2(x, s=s, dim=axes).to(torch.bfloat16))(Yf, (1, L2), axes=(-2, -1))[:, :, 0, :L]
        y = (lambda x, *d: x.permute(*d))(y, 0, 2, 1) + u * Dskip[None, None, :]
        return y

    def _B_ref(x, Lambda_re, Lambda_im, B_re, B_im, C_re, C_im, log_dt, Dskip):
        Bsz, L, H = x.shape
        Lam = Lambda_re + 1j * Lambda_im
        Bmat = B_re + 1j * B_im
        Cmat = C_re + 1j * C_im
        dt = torch.exp(log_dt)
        Lam_bar = torch.exp(dt * Lam)
        B_bar = ((Lam_bar - 1.0) / Lam)[:, None] * Bmat
        Bu = torch.einsum("bld,pd->blp", x + 0j, B_bar)
        h = torch.zeros_like(Bu[:, 0, :])
        hs = []
        for t in range(L):
            h = Lam_bar[None, :] * h + Bu[:, t, :]
            hs.append(h)
        hseq = torch.stack(hs, 1)
        y = 2.0 * torch.einsum("blp,dp->bld", hseq, Cmat).real + x * Dskip[None, None, :]
        return y

    a = _A_ref(A_u, A_A_re, A_A_im, A_B_re, A_B_im, A_C_re, A_C_im, A_log_dt, A_Dskip)
    b = _B_ref(B_x, B_Lambda_re, B_Lambda_im, B_B_re, B_B_im, B_C_re, B_C_im, B_log_dt, B_Dskip)
    return torch.concatenate([a, b], axis=-1)
```

```asm
; @launch grid=(255,1,1) block=(512,1,1) lds=163840
.amdgcn_target "amdgcn-amd-amdhsa--gfx950"
.text
.globl concat_heads__ssm_conv_s4__ssm_conv_s5__prompt_kernel
.p2align 8
.type concat_heads__ssm_conv_s4__ssm_conv_s5__prompt_kernel,@function
concat_heads__ssm_conv_s4__ssm_conv_s5__prompt_kernel:
    s_load_dwordx16 s[16:31], s[0:1], 0
    s_load_dwordx16 s[32:47], s[0:1], 64
    s_load_dwordx8 s[48:55], s[0:1], 128
    s_load_dwordx2 s[56:57], s[0:1], 160
    s_cmp_ge_u32 s2, 255
    s_cbranch_scc1 L_exit
    v_lshrrev_b32 v2, 6, v0
    v_and_b32 v1, 63, v0
    v_readfirstlane_b32 s3, v2
    s_and_b32 s4, s2, 7
    s_lshr_b32 s5, s2, 3
    s_getpc_b64 s[6:7]
L_pc:
    s_lshl_b32 s8, s5, 3
    s_add_u32 s8, s8, s3
    s_and_b32 s8, s8, 63
    s_min_u32 s8, s8, 32
    s_lshl_b32 s8, s8, 10
    s_sub_u32 s6, s6, L_pc-concat_heads__ssm_conv_s4__ssm_conv_s5__prompt_kernel
    s_subb_u32 s7, s7, 0
    s_add_u32 s6, s6, s8
    s_addc_u32 s7, s7, 0
    v_lshlrev_b32 v3, 4, v1
    global_load_dwordx4 v[252:255], v3, s[6:7]
    s_and_b32 s9, s2, 1
    s_lshl_b32 s8, s9, 2
    s_sub_u32 s8, 20, s8
    s_cmp_ge_u32 s5, s8
    s_cbranch_scc1 L_roleA
    s_mul_i32 s14, s5, 13
    s_lshr_b32 s14, s14, 6
    s_lshr_b32 s15, s5, 2
    s_cmp_eq_u32 s9, 0
    s_cselect_b32 s14, s14, s15
    s_cselect_b32 s15, 5, 4
    s_cselect_b32 s58, 0, 5
    s_mul_i32 s15, s15, s14
    s_sub_u32 s9, s5, s15
    s_add_u32 s9, s9, s58
    s_lshr_b32 s8, s4, 1
    s_lshl2_add_u32 s8, s8, s14
    s_and_b32 s10, s3, 3
    s_lshr_b32 s11, s3, 2
    s_lshl_b32 s14, s8, 7
    s_lshl_b32 s15, s3, 5
    s_add_u32 s14, s14, s15
    s_and_b32 s15, s3, 1
    s_lshl_b32 s15, s15, 5
    s_lshl_b32 s58, s9, 6
    s_add_u32 s15, s15, s58
    s_and_b32 s76, s3, 1
    s_add_u32 s76, s76, s58
    s_mul_i32 s76, s76, 1152
    s_cmp_lt_u32 s3, 4
    s_cselect_b32 s14, s14, s15
    s_movk_i32 s15, 9216
    s_cselect_b32 s15, 4608, s15
    s_cselect_b64 vcc, -1, 0
    s_mul_i32 s64, s14, 1152
    s_add_u32 s65, s64, s15
    s_add_u32 s66, s65, s15
    s_add_u32 s67, s66, s15
    s_lshl_b32 s68, s3, 12
    s_mov_b32 s71, 0
    s_mov_b32 s7, s9
    v_lshrrev_b32 v2, 3, v1
    v_and_b32 v3, 3, v2
    v_lshrrev_b32 v6, 5, v1
    v_lshl_add_u32 v3, v6, 4, v3
    v_cndmask_b32 v3, v2, v3, vcc
    v_mul_u32_u24 v3, 1152, v3
    v_lshrrev_b32 v7, 4, v1
    v_xor_b32 v7, v7, v1
    v_and_b32 v7, 7, v7
    v_lshlrev_b32 v7, 4, v7
    v_add_u32 v4, v7, v3
    v_xor_b32 v5, 64, v4
    s_lshl_b32 s15, s11, 5
    s_add_u32 s58, s58, s15
    v_and_b32 v13, 31, v1
    v_add_u32 v12, s58, v13
    v_lshlrev_b32 v12, 1, v12
    s_waitcnt lgkmcnt(0)
    global_load_ushort v240, v12, s[36:37]
    global_load_ushort v241, v12, s[38:39]
    global_load_ushort v242, v12, s[48:49]
    s_cmp_lt_u32 s3, 6
    s_cselect_b32 s60, s40, s42
    s_cselect_b32 s61, s41, s43
    s_cmp_lt_u32 s3, 4
    s_cselect_b32 s60, s34, s60
    s_cselect_b32 s61, s35, s61
    s_mov_b32 s62, 663552
    s_cselect_b32 s62, 2359296, s62
    s_mov_b32 s63, 0x20000
    s_lshl_b32 s59, s2, 3
    s_add_u32 s59, s59, s3
    s_sub_u32 s13, s59, 7
    s_cmp_lg_u32 s13, 0
    s_cbranch_scc1 L_noep_1
    v_mov_b32 v8, 0
    global_load_dword v245, v8, s[56:57] sc1
L_noep_1:
    s_add_u32 m0, s68, 4096
    s_add_u32 s14, s64, s71
    buffer_load_dwordx4 v4, s[60:63], s14 offen lds
    s_add_u32 m0, s68, 5120
    s_add_u32 s14, s65, s71
    buffer_load_dwordx4 v5, s[60:63], s14 offen lds
    s_add_u32 m0, s68, 6144
    s_add_u32 s14, s66, s71
    buffer_load_dwordx4 v4, s[60:63], s14 offen lds
    s_add_u32 m0, s68, 7168
    s_add_u32 s14, s67, s71
    buffer_load_dwordx4 v5, s[60:63], s14 offen lds
    v_mul_u32_u24 v2, 2304, v2
    v_add_u32 v246, v7, v2
    v_xor_b32 v247, 64, v246
    v_and_b32 v7, 31, v1
    s_add_u32 s71, s71, 128
    s_cmp_eq_u32 s71, 1152
    s_cselect_b32 s71, 0, s71
    s_add_u32 m0, s68, 36864
    s_add_u32 s14, s64, s71
    buffer_load_dwordx4 v4, s[60:63], s14 offen lds
    s_add_u32 m0, s68, 37888
    s_add_u32 s14, s65, s71
    buffer_load_dwordx4 v5, s[60:63], s14 offen lds
    s_add_u32 m0, s68, 38912
    s_add_u32 s14, s66, s71
    buffer_load_dwordx4 v4, s[60:63], s14 offen lds
    s_add_u32 m0, s68, 39936
    s_add_u32 s14, s67, s71
    buffer_load_dwordx4 v5, s[60:63], s14 offen lds
    s_bitcmp1_b32 s3, 1
    s_cselect_b32 s72, s46, s44
    s_cselect_b32 s73, s47, s45
    s_mov_b32 s74, 663552
    s_mov_b32 s75, 0x20000
    s_lshl_b32 s18, s9, 7
    s_add_u32 s19, s18, 128
    s_cmp_eq_u32 s19, 1152
    s_cselect_b32 s19, 0, s19
    s_add_u32 s20, s19, 128
    s_cmp_eq_u32 s20, 1152
    s_cselect_b32 s20, 0, s20
    s_add_u32 s21, s20, 128
    s_cmp_eq_u32 s21, 1152
    s_cselect_b32 s21, 0, s21
    s_add_u32 s22, s21, 128
    s_cmp_eq_u32 s22, 1152
    s_cselect_b32 s22, 0, s22
    s_add_u32 s23, s22, 128
    s_cmp_eq_u32 s23, 1152
    s_cselect_b32 s23, 0, s23
    s_add_u32 s24, s23, 128
    s_cmp_eq_u32 s24, 1152
    s_cselect_b32 s24, 0, s24
    s_add_u32 s16, s24, 128
    s_cmp_eq_u32 s16, 1152
    s_cselect_b32 s16, 0, s16
    s_add_u32 s17, s16, 128
    s_cmp_eq_u32 s17, 1152
    s_cselect_b32 s17, 0, s17
    s_cmp_eq_u32 s11, 0
    s_cselect_b32 s25, s16, s17
    s_cselect_b32 s26, s18, s19
    s_cselect_b32 s27, s20, s21
    s_cselect_b32 s28, s22, s23
    s_add_u32 s77, s76, 18432
    s_add_u32 s78, s77, 18432
    s_add_u32 s79, s78, 18432
    s_mov_b64 s[40:41], s[44:45]
    s_mov_b64 s[42:43], s[46:47]
    s_mov_b32 s80, s56
    s_mov_b32 s81, s57
    s_mov_b32 s82, 9437184
    s_mov_b32 s83, 0x20000
    s_mov_b32 s44, s52
    s_mov_b32 s45, s53
    s_mov_b32 s46, 9437184
    s_mov_b32 s47, 0x20000
    s_lshl_b32 s14, s8, 2
    s_add_u32 s14, s14, s10
    s_mul_i32 s14, s14, 72*1024
    s_add_u32 s58, s14, 1048576
    s_lshl_b32 s14, s9, 13
    s_lshl_b32 s15, s11, 12
    s_add_u32 s14, s14, s15
    s_add_u32 s6, s14, s58
    s_lshl_b32 s14, s9, 7
    v_lshl_add_u32 v9, v7, 2, s14
    global_load_dword v243, v9, s[50:51]
    v_lshrrev_b32 v2, 1, v7
    v_and_b32 v2, 7, v2
    v_xor_b32 v2, v2, v6
    v_lshlrev_b32 v2, 4, v2
    v_lshl_add_u32 v2, v7, 7, v2
    s_lshl_b32 s14, s10, 12
    s_lshl_b32 s15, s11, 12
    s_add_u32 s15, s15, 16384
    v_xor_b32 v3, 0, v2
    v_add_u32 v16, s14, v3
    v_add_u32 v24, s15, v3
    v_add_u32 v20, 0x10000, v16
    v_add_u32 v28, 0x10000, v24
    v_xor_b32 v3, 32, v2
    v_add_u32 v17, s14, v3
    v_add_u32 v25, s15, v3
    v_add_u32 v21, 0x10000, v17
    v_add_u32 v29, 0x10000, v25
    v_xor_b32 v3, 64, v2
    v_add_u32 v18, s14, v3
    v_add_u32 v26, s15, v3
    v_add_u32 v22, 0x10000, v18
    v_add_u32 v30, 0x10000, v26
    v_xor_b32 v3, 96, v2
    v_add_u32 v19, s14, v3
    v_add_u32 v27, s15, v3
    v_add_u32 v23, 0x10000, v19
    v_add_u32 v31, 0x10000, v27
    v_lshrrev_b32 v2, 2, v7
    v_lshlrev_b32 v3, 2, v6
    v_xor_b32 v2, v2, v3
    v_lshlrev_b32 v3, 4, v2
    v_lshl_add_u32 v3, v6, 10, v3
    v_and_b32 v2, 3, v7
    v_lshl_add_u32 v3, v2, 2, v3
    s_and_b32 s15, s7, 3
    s_lshl_b32 s15, s15, 15
    s_add_u32 s14, s14, s15
    v_add_u32 v208, s14, v3
    v_xor_b32 v209, 16, v208
    v_xor_b32 v210, 32, v208
    v_xor_b32 v211, 48, v208
    s_add_u32 s7, s7, s68
    s_and_b32 s7, s7, 0x400f
    s_add_u32 s14, s68, 4096
    v_bfe_u32 v8, v1, 1, 2
    v_lshlrev_b32 v2, 1, v6
    v_xor_b32 v8, v8, v2
    v_lshlrev_b32 v8, 4, v8
    v_lshl_add_u32 v8, v7, 6, v8
    v_add_u32 v212, s14, v8
    v_xor_b32 v213, 16, v212
    v_bfe_u32 v2, v1, 2, 2
    v_lshlrev_b32 v9, 6, v2
    v_lshl_add_u32 v9, v6, 11, v9
    v_lshrrev_b32 v2, 1, v2
    v_bfe_u32 v10, v1, 4, 1
    v_lshlrev_b32 v10, 1, v10
    v_xor_b32 v2, v2, v10
    v_bfe_u32 v10, v1, 1, 1
    v_xor_b32 v2, v2, v10
    v_lshl_add_u32 v9, v2, 4, v9
    v_and_b32 v2, 1, v1
    v_lshl_add_u32 v9, v2, 3, v9
    v_add_u32 v214, s14, v9
    v_xor_b32 v215, 32, v214
    s_lshl2_add_u32 s30, s8, s10
    s_lshl_b32 s30, s30, 7
    s_add_u32 s30, s30, 262144
    s_waitcnt vmcnt(9)
    v_lshlrev_b32 v240, 16, v240
    v_lshlrev_b32 v241, 16, v241
    v_lshlrev_b32 v242, 16, v242
    v_mul_f32 v10, 1069066811, v242
    v_exp_f32 v10, v10
    s_nop 0
    v_cvt_pk_bf16_f32 v10, v10, v10
    v_lshlrev_b32 v10, 16, v10
    v_mul_f32 v236, v10, v240
    v_mul_f32 v237, v10, v241
    v_mul_f32 v236, 1069066811, v236
    v_mul_f32 v237, 0.15915494, v237
    v_exp_f32 v10, v236
    v_fract_f32 v11, v237
    v_cos_f32 v216, v11
    v_sin_f32 v217, v11
    v_mul_f32 v216, v10, v216
    v_mul_f32 v217, v10, v217
    v_sub_f32 v218, 0, v217
    v_mul_f32 v10, 0x41800000, v236
    v_mul_f32 v11, 0x41800000, v237
    v_exp_f32 v10, v10
    v_fract_f32 v11, v11
    v_cos_f32 v220, v11
    v_sin_f32 v221, v11
    v_mul_f32 v220, v10, v220
    v_mul_f32 v221, v10, v221
    v_mul_f32 v10, v240, v240
    v_fmac_f32 v10, v241, v241
    v_rcp_f32 v10, v10
    v_add_f32 v11, -1.0, v216
    v_mul_f32 v12, v11, v240
    v_fmac_f32 v12, v217, v241
    v_mul_f32 v13, v217, v240
    v_fma_f32 v13, -v11, v241, v13
    v_add_f32 v10, v10, v10
    v_mul_f32 v222, v12, v10
    v_mul_f32 v223, v13, v10
    v_pk_mul_f32 v[12:13], v[222:223], v[216:217] op_sel:[0,0] op_sel_hi:[0,1]
    v_pk_fma_f32 v[12:13], v[222:223], v[216:217], v[12:13] op_sel:[1,1,0] op_sel_hi:[1,0,1] neg_lo:[0,1,0]
    v_pk_mul_f32 v[14:15], v[12:13], v[216:217] op_sel:[0,0] op_sel_hi:[0,1]
    v_pk_fma_f32 v[14:15], v[12:13], v[216:217], v[14:15] op_sel:[1,1,0] op_sel_hi:[1,0,1] neg_lo:[0,1,0]
    v_pk_mul_f32 v[10:11], v[216:217], v[216:217] op_sel:[0,0] op_sel_hi:[0,1]
    v_pk_fma_f32 v[10:11], v[216:217], v[216:217], v[10:11] op_sel:[1,1,0] op_sel_hi:[1,0,1] neg_lo:[0,1,0]
    v_mov_b32 v144, v12
    v_mov_b32 v160, v13
    v_mov_b32 v145, v14
    v_mov_b32 v161, v15
    v_pk_mul_f32 v[146:147], v[144:145], v[10:11] op_sel:[0,0] op_sel_hi:[1,0]
    v_pk_mul_f32 v[162:163], v[160:161], v[10:11] op_sel:[0,0] op_sel_hi:[1,0]
    v_pk_fma_f32 v[146:147], v[160:161], v[10:11], v[146:147] op_sel:[0,1,0] op_sel_hi:[1,1,1] neg_lo:[0,1,0] neg_hi:[0,1,0]
    v_pk_fma_f32 v[162:163], v[144:145], v[10:11], v[162:163] op_sel:[0,1,0] op_sel_hi:[1,1,1]
    v_pk_mul_f32 v[148:149], v[146:147], v[10:11] op_sel:[0,0] op_sel_hi:[1,0]
    v_pk_mul_f32 v[164:165], v[162:163], v[10:11] op_sel:[0,0] op_sel_hi:[1,0]
    v_pk_fma_f32 v[148:149], v[162:163], v[10:11], v[148:149] op_sel:[0,1,0] op_sel_hi:[1,1,1] neg_lo:[0,1,0] neg_hi:[0,1,0]
    v_pk_fma_f32 v[164:165], v[146:147], v[10:11], v[164:165] op_sel:[0,1,0] op_sel_hi:[1,1,1]
    v_pk_mul_f32 v[150:151], v[148:149], v[10:11] op_sel:[0,0] op_sel_hi:[1,0]
    v_pk_mul_f32 v[166:167], v[164:165], v[10:11] op_sel:[0,0] op_sel_hi:[1,0]
    v_pk_fma_f32 v[150:151], v[164:165], v[10:11], v[150:151] op_sel:[0,1,0] op_sel_hi:[1,1,1] neg_lo:[0,1,0] neg_hi:[0,1,0]
    v_pk_fma_f32 v[166:167], v[148:149], v[10:11], v[166:167] op_sel:[0,1,0] op_sel_hi:[1,1,1]
    v_pk_mul_f32 v[152:153], v[150:151], v[10:11] op_sel:[0,0] op_sel_hi:[1,0]
    v_pk_mul_f32 v[168:169], v[166:167], v[10:11] op_sel:[0,0] op_sel_hi:[1,0]
    v_pk_fma_f32 v[152:153], v[166:167], v[10:11], v[152:153] op_sel:[0,1,0] op_sel_hi:[1,1,1] neg_lo:[0,1,0] neg_hi:[0,1,0]
    v_pk_fma_f32 v[168:169], v[150:151], v[10:11], v[168:169] op_sel:[0,1,0] op_sel_hi:[1,1,1]
    v_pk_mul_f32 v[154:155], v[152:153], v[10:11] op_sel:[0,0] op_sel_hi:[1,0]
    v_pk_mul_f32 v[170:171], v[168:169], v[10:11] op_sel:[0,0] op_sel_hi:[1,0]
    v_pk_fma_f32 v[154:155], v[168:169], v[10:11], v[154:155] op_sel:[0,1,0] op_sel_hi:[1,1,1] neg_lo:[0,1,0] neg_hi:[0,1,0]
    v_pk_fma_f32 v[170:171], v[152:153], v[10:11], v[170:171] op_sel:[0,1,0] op_sel_hi:[1,1,1]
    v_pk_mul_f32 v[156:157], v[154:155], v[10:11] op_sel:[0,0] op_sel_hi:[1,0]
    v_pk_mul_f32 v[172:173], v[170:171], v[10:11] op_sel:[0,0] op_sel_hi:[1,0]
    v_pk_fma_f32 v[156:157], v[170:171], v[10:11], v[156:157] op_sel:[0,1,0] op_sel_hi:[1,1,1] neg_lo:[0,1,0] neg_hi:[0,1,0]
    v_pk_fma_f32 v[172:173], v[154:155], v[10:11], v[172:173] op_sel:[0,1,0] op_sel_hi:[1,1,1]
    v_pk_mul_f32 v[158:159], v[156:157], v[10:11] op_sel:[0,0] op_sel_hi:[1,0]
    v_pk_mul_f32 v[174:175], v[172:173], v[10:11] op_sel:[0,0] op_sel_hi:[1,0]
    v_pk_fma_f32 v[158:159], v[172:173], v[10:11], v[158:159] op_sel:[0,1,0] op_sel_hi:[1,1,1] neg_lo:[0,1,0] neg_hi:[0,1,0]
    v_pk_fma_f32 v[174:175], v[156:157], v[10:11], v[174:175] op_sel:[0,1,0] op_sel_hi:[1,1,1]
    s_lshl_b32 s14, s10, 1
    v_add_u32 v13, s14, v6
    v_lshlrev_b32 v13, 4, v13
    v_cvt_f32_u32 v13, v13
    v_mul_f32 v10, v13, v236
    v_mul_f32 v11, v13, v237
    v_exp_f32 v10, v10
    v_fract_f32 v11, v11
    v_cos_f32 v230, v11
    v_sin_f32 v231, v11
    v_mul_f32 v230, v10, v230
    v_mul_f32 v231, v10, v231
    v_mul_f32 v10, 0x43800000, v236
    v_mul_f32 v11, 0x43800000, v237
    v_exp_f32 v10, v10
    v_fract_f32 v11, v11
    v_cos_f32 v226, v11
    v_sin_f32 v227, v11
    v_mul_f32 v226, v10, v226
    v_mul_f32 v227, v10, v227
    v_lshlrev_b32 v13, 7, v6
    v_cvt_f32_u32 v13, v13
    v_mul_f32 v10, v13, v236
    v_mul_f32 v11, v13, v237
    v_exp_f32 v10, v10
    v_fract_f32 v11, v11
    v_cos_f32 v176, v11
    v_sin_f32 v177, v11
    v_mul_f32 v176, v10, v176
    v_mul_f32 v177, v10, v177
    v_pk_mul_f32 v[178:179], v[176:177], v[226:227] op_sel:[0,0] op_sel_hi:[0,1]
    v_pk_fma_f32 v[178:179], v[176:177], v[226:227], v[178:179] op_sel:[1,1,0] op_sel_hi:[1,0,1] neg_lo:[0,1,0]
    v_pk_mul_f32 v[180:181], v[178:179], v[226:227] op_sel:[0,0] op_sel_hi:[0,1]
    v_pk_fma_f32 v[180:181], v[178:179], v[226:227], v[180:181] op_sel:[1,1,0] op_sel_hi:[1,0,1] neg_lo:[0,1,0]
    v_pk_mul_f32 v[182:183], v[180:181], v[226:227] op_sel:[0,0] op_sel_hi:[0,1]
    v_pk_fma_f32 v[182:183], v[180:181], v[226:227], v[182:183] op_sel:[1,1,0] op_sel_hi:[1,0,1] neg_lo:[0,1,0]
    v_pk_mul_f32 v[184:185], v[182:183], v[226:227] op_sel:[0,0] op_sel_hi:[0,1]
    v_pk_fma_f32 v[184:185], v[182:183], v[226:227], v[184:185] op_sel:[1,1,0] op_sel_hi:[1,0,1] neg_lo:[0,1,0]
    v_pk_mul_f32 v[186:187], v[184:185], v[226:227] op_sel:[0,0] op_sel_hi:[0,1]
    v_pk_fma_f32 v[186:187], v[184:185], v[226:227], v[186:187] op_sel:[1,1,0] op_sel_hi:[1,0,1] neg_lo:[0,1,0]
    v_pk_mul_f32 v[188:189], v[186:187], v[226:227] op_sel:[0,0] op_sel_hi:[0,1]
    v_pk_fma_f32 v[188:189], v[186:187], v[226:227], v[188:189] op_sel:[1,1,0] op_sel_hi:[1,0,1] neg_lo:[0,1,0]
    v_pk_mul_f32 v[190:191], v[188:189], v[226:227] op_sel:[0,0] op_sel_hi:[0,1]
    v_pk_fma_f32 v[190:191], v[188:189], v[226:227], v[190:191] op_sel:[1,1,0] op_sel_hi:[1,0,1] neg_lo:[0,1,0]
    s_waitcnt vmcnt(5)
    s_barrier
    s_cmp_lg_u32 s7, 0
    s_cbranch_scc1 L_nox_2
    ds_read_b32 v192, v208 offset:4096
    ds_read_b32 v193, v208 offset:4224
    ds_read_b32 v194, v209 offset:4352
    ds_read_b32 v195, v209 offset:4480
    ds_read_b32 v196, v208 offset:6144
    ds_read_b32 v197, v208 offset:6272
    ds_read_b32 v198, v209 offset:6400
    ds_read_b32 v199, v209 offset:6528
    ds_read_b32 v200, v210 offset:4608
    ds_read_b32 v201, v210 offset:4736
    ds_read_b32 v202, v211 offset:4864
    ds_read_b32 v203, v211 offset:4992
    ds_read_b32 v204, v210 offset:6656
    ds_read_b32 v205, v210 offset:6784
    ds_read_b32 v206, v211 offset:6912
    ds_read_b32 v207, v211 offset:7040
L_nox_2:
    ds_read_b128 v[96:99], v16 offset:4096
    ds_read_b128 v[100:103], v24 offset:4096
    ds_read_b128 v[104:107], v24 offset:12288
    ds_read_b128 v[108:111], v17 offset:4096
    ds_read_b128 v[112:115], v25 offset:4096
    ds_read_b128 v[116:119], v25 offset:12288
    s_cmp_lg_u32 s13, 0
    s_cbranch_scc1 L_noep_3
    s_mov_b64 exec, 1
    v_add_u32 v245, 1, v245
    v_max_u32 v245, 1, v245
    v_mov_b32 v8, 0
    global_store_dword v8, v245, s[54:55] sc1
    global_store_dword v8, v245, s[56:57] sc1
    s_mov_b64 exec, -1
L_noep_3:
    s_waitcnt lgkmcnt(4)
    v_mfma_f32_32x32x16_bf16 v[64:79], v[96:99], v[100:103], 0
    ds_read_b128 v[120:123], v18 offset:4096
    ds_read_b128 v[124:127], v26 offset:4096
    s_waitcnt lgkmcnt(5)
    v_mfma_f32_32x32x16_bf16 v[80:95], v[96:99], v[104:107], 0
    ds_read_b128 v[128:131], v26 offset:12288
    ds_read_b128 v[132:135], v19 offset:4096
    s_add_u32 s71, s71, 128
    s_cmp_eq_u32 s71, 1152
    s_cselect_b32 s71, 0, s71
    s_add_u32 m0, s68, 69632
    s_add_u32 s14, s64, s71
    buffer_load_dwordx4 v4, s[60:63], s14 offen lds
    s_add_u32 m0, s68, 70656
    s_add_u32 s14, s65, s71
    buffer_load_dwordx4 v5, s[60:63], s14 offen lds
    s_waitcnt lgkmcnt(5)
    v_mfma_f32_32x32x16_bf16 v[64:79], v[108:111], v[112:115], v[64:79]
    ds_read_b128 v[136:139], v27 offset:4096
    ds_read_b128 v[140:143], v27 offset:12288
    s_waitcnt lgkmcnt(6)
    v_mfma_f32_32x32x16_bf16 v[80:95], v[108:111], v[116:119], v[80:95]
    s_add_u32 m0, s68, 71680
    s_add_u32 s14, s66, s71
    buffer_load_dwordx4 v4, s[60:63], s14 offen lds
    s_add_u32 m0, s68, 72704
    s_add_u32 s14, s67, s71
    buffer_load_dwordx4 v5, s[60:63], s14 offen lds
    s_waitcnt vmcnt(5) lgkmcnt(0)
    s_barrier
    v_mfma_f32_32x32x16_bf16 v[64:79], v[120:123], v[124:127], v[64:79]
    ds_read_b128 v[96:99], v16 offset:36864
    ds_read_b128 v[100:103], v24 offset:36864
    v_mfma_f32_32x32x16_bf16 v[80:95], v[120:123], v[128:131], v[80:95]
    ds_read_b128 v[104:107], v24 offset:45056
    ds_read_b128 v[108:111], v17 offset:36864
    s_add_u32 s71, s71, 128
    s_cmp_eq_u32 s71, 1152
    s_cselect_b32 s71, 0, s71
    s_add_u32 m0, s68, 102400
    s_add_u32 s14, s64, s71
    buffer_load_dwordx4 v4, s[60:63], s14 offen lds
    s_add_u32 m0, s68, 103424
    s_add_u32 s14, s65, s71
    buffer_load_dwordx4 v5, s[60:63], s14 offen lds
    v_mfma_f32_32x32x16_bf16 v[64:79], v[132:135], v[136:139], v[64:79]
    ds_read_b128 v[112:115], v25 offset:36864
    ds_read_b128 v[116:119], v25 offset:45056
    v_mfma_f32_32x32x16_bf16 v[80:95], v[132:135], v[140:143], v[80:95]
    s_add_u32 m0, s68, 104448
    s_add_u32 s14, s66, s71
    buffer_load_dwordx4 v4, s[60:63], s14 offen lds
    s_add_u32 m0, s68, 105472
    s_add_u32 s14, s67, s71
    buffer_load_dwordx4 v5, s[60:63], s14 offen lds
    s_cmp_lg_u32 s7, 1
    s_cbranch_scc1 L_nox_4
    ds_read_b32 v192, v208 offset:4096
    ds_read_b32 v193, v208 offset:4224
    ds_read_b32 v194, v209 offset:4352
    ds_read_b32 v195, v209 offset:4480
    ds_read_b32 v196, v208 offset:6144
    ds_read_b32 v197, v208 offset:6272
    ds_read_b32 v198, v209 offset:6400
    ds_read_b32 v199, v209 offset:6528
    ds_read_b32 v200, v210 offset:4608
    ds_read_b32 v201, v210 offset:4736
    ds_read_b32 v202, v211 offset:4864
    ds_read_b32 v203, v211 offset:4992
    ds_read_b32 v204, v210 offset:6656
    ds_read_b32 v205, v210 offset:6784
    ds_read_b32 v206, v211 offset:6912
    ds_read_b32 v207, v211 offset:7040
L_nox_4:
    s_waitcnt lgkmcnt(4)
    v_mfma_f32_32x32x16_bf16 v[64:79], v[96:99], v[100:103], v[64:79]
    ds_read_b128 v[120:123], v18 offset:36864
    ds_read_b128 v[124:127], v26 offset:36864
    s_waitcnt lgkmcnt(5)
    v_mfma_f32_32x32x16_bf16 v[80:95], v[96:99], v[104:107], v[80:95]
    ds_read_b128 v[128:131], v26 offset:45056
    ds_read_b128 v[132:135], v19 offset:36864
    s_add_u32 s71, s71, 128
    s_cmp_eq_u32 s71, 1152
    s_cselect_b32 s71, 0, s71
    s_add_u32 m0, s68, 4096
    s_add_u32 s14, s64, s71
    buffer_load_dwordx4 v4, s[60:63], s14 offen lds
    s_waitcnt lgkmcnt(5)
    v_mfma_f32_32x32x16_bf16 v[64:79], v[108:111], v[112:115], v[64:79]
    ds_read_b128 v[136:139], v27 offset:36864
    ds_read_b128 v[140:143], v27 offset:45056
    s_waitcnt lgkmcnt(6)
    v_mfma_f32_32x32x16_bf16 v[80:95], v[108:111], v[116:119], v[80:95]
    s_add_u32 m0, s68, 5120
    s_add_u32 s14, s65, s71
    buffer_load_dwordx4 v5, s[60:63], s14 offen lds
    s_waitcnt vmcnt(6) lgkmcnt(0)
    s_barrier
    v_mfma_f32_32x32x16_bf16 v[64:79], v[120:123], v[124:127], v[64:79]
    ds_read_b128 v[96:99], v20 offset:4096
    ds_read_b128 v[100:103], v28 offset:4096
    v_mfma_f32_32x32x16_bf16 v[80:95], v[120:123], v[128:131], v[80:95]
    ds_read_b128 v[104:107], v28 offset:12288
    ds_read_b128 v[108:111], v21 offset:4096
    s_add_u32 m0, s68, 6144
    s_add_u32 s14, s66, s71
    buffer_load_dwordx4 v4, s[60:63], s14 offen lds
    v_mfma_f32_32x32x16_bf16 v[64:79], v[132:135], v[136:139], v[64:79]
    ds_read_b128 v[112:115], v29 offset:4096
    ds_read_b128 v[116:119], v29 offset:12288
    v_mfma_f32_32x32x16_bf16 v[80:95], v[132:135], v[140:143], v[80:95]
    s_add_u32 m0, s68, 7168
    s_add_u32 s14, s67, s71
    buffer_load_dwordx4 v5, s[60:63], s14 offen lds
    s_cmp_lg_u32 s7, 2
    s_cbranch_scc1 L_nox_5
    ds_read_b32 v192, v208 offset:4096
    ds_read_b32 v193, v208 offset:4224
    ds_read_b32 v194, v209 offset:4352
    ds_read_b32 v195, v209 offset:4480
    ds_read_b32 v196, v208 offset:6144
    ds_read_b32 v197, v208 offset:6272
    ds_read_b32 v198, v209 offset:6400
    ds_read_b32 v199, v209 offset:6528
    ds_read_b32 v200, v210 offset:4608
    ds_read_b32 v201, v210 offset:4736
    ds_read_b32 v202, v211 offset:4864
    ds_read_b32 v203, v211 offset:4992
    ds_read_b32 v204, v210 offset:6656
    ds_read_b32 v205, v210 offset:6784
    ds_read_b32 v206, v211 offset:6912
    ds_read_b32 v207, v211 offset:7040
L_nox_5:
    s_waitcnt lgkmcnt(4)
    v_mfma_f32_32x32x16_bf16 v[64:79], v[96:99], v[100:103], v[64:79]
    ds_read_b128 v[120:123], v22 offset:4096
    ds_read_b128 v[124:127], v30 offset:4096
    s_waitcnt lgkmcnt(5)
    v_mfma_f32_32x32x16_bf16 v[80:95], v[96:99], v[104:107], v[80:95]
    ds_read_b128 v[128:131], v30 offset:12288
    ds_read_b128 v[132:135], v23 offset:4096
    s_add_u32 s71, s71, 128
    s_cmp_eq_u32 s71, 1152
    s_cselect_b32 s71, 0, s71
    s_add_u32 m0, s68, 36864
    s_add_u32 s14, s64, s71
    buffer_load_dwordx4 v4, s[60:63], s14 offen lds
    s_waitcnt lgkmcnt(5)
    v_mfma_f32_32x32x16_bf16 v[64:79], v[108:111], v[112:115], v[64:79]
    ds_read_b128 v[136:139], v31 offset:4096
    ds_read_b128 v[140:143], v31 offset:12288
    s_waitcnt lgkmcnt(6)
    v_mfma_f32_32x32x16_bf16 v[80:95], v[108:111], v[116:119], v[80:95]
    s_add_u32 m0, s68, 37888
    s_add_u32 s14, s65, s71
    buffer_load_dwordx4 v5, s[60:63], s14 offen lds
    s_waitcnt vmcnt(6) lgkmcnt(0)
    s_barrier
    v_mfma_f32_32x32x16_bf16 v[64:79], v[120:123], v[124:127], v[64:79]
    ds_read_b128 v[96:99], v20 offset:36864
    ds_read_b128 v[100:103], v28 offset:36864
    v_mfma_f32_32x32x16_bf16 v[80:95], v[120:123], v[128:131], v[80:95]
    ds_read_b128 v[104:107], v28 offset:45056
    ds_read_b128 v[108:111], v21 offset:36864
    s_add_u32 m0, s68, 38912
    s_add_u32 s14, s66, s71
    buffer_load_dwordx4 v4, s[60:63], s14 offen lds
    v_mfma_f32_32x32x16_bf16 v[64:79], v[132:135], v[136:139], v[64:79]
    ds_read_b128 v[112:115], v29 offset:36864
    ds_read_b128 v[116:119], v29 offset:45056
    v_mfma_f32_32x32x16_bf16 v[80:95], v[132:135], v[140:143], v[80:95]
    s_add_u32 m0, s68, 39936
    s_add_u32 s14, s67, s71
    buffer_load_dwordx4 v5, s[60:63], s14 offen lds
    s_cmp_lg_u32 s7, 3
    s_cbranch_scc1 L_nox_6
    ds_read_b32 v192, v208 offset:4096
    ds_read_b32 v193, v208 offset:4224
    ds_read_b32 v194, v209 offset:4352
    ds_read_b32 v195, v209 offset:4480
    ds_read_b32 v196, v208 offset:6144
    ds_read_b32 v197, v208 offset:6272
    ds_read_b32 v198, v209 offset:6400
    ds_read_b32 v199, v209 offset:6528
    ds_read_b32 v200, v210 offset:4608
    ds_read_b32 v201, v210 offset:4736
    ds_read_b32 v202, v211 offset:4864
    ds_read_b32 v203, v211 offset:4992
    ds_read_b32 v204, v210 offset:6656
    ds_read_b32 v205, v210 offset:6784
    ds_read_b32 v206, v211 offset:6912
    ds_read_b32 v207, v211 offset:7040
L_nox_6:
    s_waitcnt lgkmcnt(4)
    v_mfma_f32_32x32x16_bf16 v[64:79], v[96:99], v[100:103], v[64:79]
    ds_read_b128 v[120:123], v22 offset:36864
    ds_read_b128 v[124:127], v30 offset:36864
    s_waitcnt lgkmcnt(5)
    v_mfma_f32_32x32x16_bf16 v[80:95], v[96:99], v[104:107], v[80:95]
    ds_read_b128 v[128:131], v30 offset:45056
    ds_read_b128 v[132:135], v23 offset:36864
    s_add_u32 s71, s71, 128
    s_cmp_eq_u32 s71, 1152
    s_cselect_b32 s71, 0, s71
    s_add_u32 m0, s68, 69632
    s_add_u32 s14, s64, s71
    buffer_load_dwordx4 v4, s[60:63], s14 offen lds
    s_waitcnt lgkmcnt(5)
    v_mfma_f32_32x32x16_bf16 v[64:79], v[108:111], v[112:115], v[64:79]
    ds_read_b128 v[136:139], v31 offset:36864
    ds_read_b128 v[140:143], v31 offset:45056
    s_waitcnt lgkmcnt(6)
    v_mfma_f32_32x32x16_bf16 v[80:95], v[108:111], v[116:119], v[80:95]
    s_add_u32 m0, s68, 70656
    s_add_u32 s14, s65, s71
    buffer_load_dwordx4 v5, s[60:63], s14 offen lds
    s_waitcnt vmcnt(6) lgkmcnt(0)
    s_barrier
    v_mfma_f32_32x32x16_bf16 v[64:79], v[120:123], v[124:127], v[64:79]
    ds_read_b128 v[96:99], v16 offset:4096
    ds_read_b128 v[100:103], v24 offset:4096
    v_mfma_f32_32x32x16_bf16 v[80:95], v[120:123], v[128:131], v[80:95]
    ds_read_b128 v[104:107], v24 offset:12288
    ds_read_b128 v[108:111], v17 offset:4096
    s_add_u32 m0, s68, 71680
    s_add_u32 s14, s66, s71
    buffer_load_dwordx4 v4, s[60:63], s14 offen lds
    v_mfma_f32_32x32x16_bf16 v[64:79], v[132:135], v[136:139], v[64:79]
    ds_read_b128 v[112:115], v25 offset:4096
    ds_read_b128 v[116:119], v25 offset:12288
    v_mfma_f32_32x32x16_bf16 v[80:95], v[132:135], v[140:143], v[80:95]
    s_add_u32 m0, s68, 72704
    s_add_u32 s14, s67, s71
    buffer_load_dwordx4 v5, s[60:63], s14 offen lds
    s_cmp_lg_u32 s7, 4
    s_cbranch_scc1 L_nox_7
    ds_read_b32 v192, v208 offset:4096
    ds_read_b32 v193, v208 offset:4224
    ds_read_b32 v194, v209 offset:4352
    ds_read_b32 v195, v209 offset:4480
    ds_read_b32 v196, v208 offset:6144
    ds_read_b32 v197, v208 offset:6272
    ds_read_b32 v198, v209 offset:6400
    ds_read_b32 v199, v209 offset:6528
    ds_read_b32 v200, v210 offset:4608
    ds_read_b32 v201, v210 offset:4736
    ds_read_b32 v202, v211 offset:4864
    ds_read_b32 v203, v211 offset:4992
    ds_read_b32 v204, v210 offset:6656
    ds_read_b32 v205, v210 offset:6784
    ds_read_b32 v206, v211 offset:6912
    ds_read_b32 v207, v211 offset:7040
L_nox_7:
    s_waitcnt lgkmcnt(4)
    v_mfma_f32_32x32x16_bf16 v[64:79], v[96:99], v[100:103], v[64:79]
    ds_read_b128 v[120:123], v18 offset:4096
    ds_read_b128 v[124:127], v26 offset:4096
    s_waitcnt lgkmcnt(5)
    v_mfma_f32_32x32x16_bf16 v[80:95], v[96:99], v[104:107], v[80:95]
    ds_read_b128 v[128:131], v26 offset:12288
    ds_read_b128 v[132:135], v19 offset:4096
    s_add_u32 s71, s71, 128
    s_cmp_eq_u32 s71, 1152
    s_cselect_b32 s71, 0, s71
    s_add_u32 m0, s68, 102400
    s_add_u32 s14, s64, s71
    buffer_load_dwordx4 v4, s[60:63], s14 offen lds
    s_waitcnt lgkmcnt(5)
    v_mfma_f32_32x32x16_bf16 v[64:79], v[108:111], v[112:115], v[64:79]
    ds_read_b128 v[136:139], v27 offset:4096
    ds_read_b128 v[140:143], v27 offset:12288
    s_waitcnt lgkmcnt(6)
    v_mfma_f32_32x32x16_bf16 v[80:95], v[108:111], v[116:119], v[80:95]
    s_add_u32 m0, s68, 103424
    s_add_u32 s14, s65, s71
    buffer_load_dwordx4 v5, s[60:63], s14 offen lds
    s_waitcnt vmcnt(6) lgkmcnt(0)
    s_barrier
    v_mfma_f32_32x32x16_bf16 v[64:79], v[120:123], v[124:127], v[64:79]
    ds_read_b128 v[96:99], v16 offset:36864
    ds_read_b128 v[100:103], v24 offset:36864
    v_mfma_f32_32x32x16_bf16 v[80:95], v[120:123], v[128:131], v[80:95]
    ds_read_b128 v[104:107], v24 offset:45056
    ds_read_b128 v[108:111], v17 offset:36864
    s_add_u32 m0, s68, 104448
    s_add_u32 s14, s66, s71
    buffer_load_dwordx4 v4, s[60:63], s14 offen lds
    v_mfma_f32_32x32x16_bf16 v[64:79], v[132:135], v[136:139], v[64:79]
    ds_read_b128 v[112:115], v25 offset:36864
    ds_read_b128 v[116:119], v25 offset:45056
    v_mfma_f32_32x32x16_bf16 v[80:95], v[132:135], v[140:143], v[80:95]
    s_add_u32 m0, s68, 105472
    s_add_u32 s14, s67, s71
    buffer_load_dwordx4 v5, s[60:63], s14 offen lds
    s_cmp_lg_u32 s7, 5
    s_cbranch_scc1 L_nox_8
    ds_read_b32 v192, v208 offset:4096
    ds_read_b32 v193, v208 offset:4224
    ds_read_b32 v194, v209 offset:4352
    ds_read_b32 v195, v209 offset:4480
    ds_read_b32 v196, v208 offset:6144
    ds_read_b32 v197, v208 offset:6272
    ds_read_b32 v198, v209 offset:6400
    ds_read_b32 v199, v209 offset:6528
    ds_read_b32 v200, v210 offset:4608
    ds_read_b32 v201, v210 offset:4736
    ds_read_b32 v202, v211 offset:4864
    ds_read_b32 v203, v211 offset:4992
    ds_read_b32 v204, v210 offset:6656
    ds_read_b32 v205, v210 offset:6784
    ds_read_b32 v206, v211 offset:6912
    ds_read_b32 v207, v211 offset:7040
L_nox_8:
    v_mov_b32 v2, 0
    global_load_dword v245, v2, s[54:55] sc1
    s_waitcnt lgkmcnt(4)
    v_mfma_f32_32x32x16_bf16 v[64:79], v[96:99], v[100:103], v[64:79]
    ds_read_b128 v[120:123], v18 offset:36864
    ds_read_b128 v[124:127], v26 offset:36864
    s_waitcnt lgkmcnt(5)
    v_mfma_f32_32x32x16_bf16 v[80:95], v[96:99], v[104:107], v[80:95]
    ds_read_b128 v[128:131], v26 offset:45056
    ds_read_b128 v[132:135], v19 offset:36864
    s_add_u32 s71, s71, 128
    s_cmp_eq_u32 s71, 1152
    s_cselect_b32 s71, 0, s71
    s_add_u32 m0, s68, 4096
    s_add_u32 s14, s64, s71
    buffer_load_dwordx4 v4, s[60:63], s14 offen lds
    s_waitcnt lgkmcnt(5)
    v_mfma_f32_32x32x16_bf16 v[64:79], v[108:111], v[112:115], v[64:79]
    ds_read_b128 v[136:139], v27 offset:36864
    ds_read_b128 v[140:143], v27 offset:45056
    s_waitcnt lgkmcnt(6)
    v_mfma_f32_32x32x16_bf16 v[80:95], v[108:111], v[116:119], v[80:95]
    s_add_u32 m0, s68, 5120
    s_add_u32 s14, s65, s71
    buffer_load_dwordx4 v5, s[60:63], s14 offen lds
    s_waitcnt vmcnt(7) lgkmcnt(0)
    s_barrier
    v_mfma_f32_32x32x16_bf16 v[64:79], v[120:123], v[124:127], v[64:79]
    ds_read_b128 v[96:99], v20 offset:4096
    ds_read_b128 v[100:103], v28 offset:4096
    v_mfma_f32_32x32x16_bf16 v[80:95], v[120:123], v[128:131], v[80:95]
    ds_read_b128 v[104:107], v28 offset:12288
    ds_read_b128 v[108:111], v21 offset:4096
    s_add_u32 m0, s68, 6144
    s_add_u32 s14, s66, s71
    buffer_load_dwordx4 v4, s[60:63], s14 offen lds
    v_mfma_f32_32x32x16_bf16 v[64:79], v[132:135], v[136:139], v[64:79]
    ds_read_b128 v[112:115], v29 offset:4096
    ds_read_b128 v[116:119], v29 offset:12288
    v_mfma_f32_32x32x16_bf16 v[80:95], v[132:135], v[140:143], v[80:95]
    s_add_u32 m0, s68, 7168
    s_add_u32 s14, s67, s71
    buffer_load_dwordx4 v5, s[60:63], s14 offen lds
    s_cmp_lg_u32 s7, 6
    s_cbranch_scc1 L_nox_9
    ds_read_b32 v192, v208 offset:4096
    ds_read_b32 v193, v208 offset:4224
    ds_read_b32 v194, v209 offset:4352
    ds_read_b32 v195, v209 offset:4480
    ds_read_b32 v196, v208 offset:6144
    ds_read_b32 v197, v208 offset:6272
    ds_read_b32 v198, v209 offset:6400
    ds_read_b32 v199, v209 offset:6528
    ds_read_b32 v200, v210 offset:4608
    ds_read_b32 v201, v210 offset:4736
    ds_read_b32 v202, v211 offset:4864
    ds_read_b32 v203, v211 offset:4992
    ds_read_b32 v204, v210 offset:6656
    ds_read_b32 v205, v210 offset:6784
    ds_read_b32 v206, v211 offset:6912
    ds_read_b32 v207, v211 offset:7040
L_nox_9:
    s_waitcnt lgkmcnt(4)
    v_mfma_f32_32x32x16_bf16 v[64:79], v[96:99], v[100:103], v[64:79]
    ds_read_b128 v[120:123], v22 offset:4096
    ds_read_b128 v[124:127], v30 offset:4096
    s_waitcnt lgkmcnt(5)
    v_mfma_f32_32x32x16_bf16 v[80:95], v[96:99], v[104:107], v[80:95]
    ds_read_b128 v[128:131], v30 offset:12288
    ds_read_b128 v[132:135], v23 offset:4096
    s_waitcnt lgkmcnt(5)
    v_mfma_f32_32x32x16_bf16 v[64:79], v[108:111], v[112:115], v[64:79]
    ds_read_b128 v[136:139], v31 offset:4096
    ds_read_b128 v[140:143], v31 offset:12288
    s_waitcnt lgkmcnt(6)
    v_mfma_f32_32x32x16_bf16 v[80:95], v[108:111], v[116:119], v[80:95]
    s_waitcnt vmcnt(5) lgkmcnt(0)
    s_barrier
    v_mfma_f32_32x32x16_bf16 v[64:79], v[120:123], v[124:127], v[64:79]
    ds_read_b128 v[96:99], v20 offset:36864
    ds_read_b128 v[100:103], v28 offset:36864
    v_mfma_f32_32x32x16_bf16 v[80:95], v[120:123], v[128:131], v[80:95]
    ds_read_b128 v[104:107], v28 offset:45056
    ds_read_b128 v[108:111], v21 offset:36864
    v_mfma_f32_32x32x16_bf16 v[64:79], v[132:135], v[136:139], v[64:79]
    ds_read_b128 v[112:115], v29 offset:36864
    ds_read_b128 v[116:119], v29 offset:45056
    v_mfma_f32_32x32x16_bf16 v[80:95], v[132:135], v[140:143], v[80:95]
    s_cmp_lg_u32 s7, 7
    s_cbranch_scc1 L_nox_10
    ds_read_b32 v192, v208 offset:4096
    ds_read_b32 v193, v208 offset:4224
    ds_read_b32 v194, v209 offset:4352
    ds_read_b32 v195, v209 offset:4480
    ds_read_b32 v196, v208 offset:6144
    ds_read_b32 v197, v208 offset:6272
    ds_read_b32 v198, v209 offset:6400
    ds_read_b32 v199, v209 offset:6528
    ds_read_b32 v200, v210 offset:4608
    ds_read_b32 v201, v210 offset:4736
    ds_read_b32 v202, v211 offset:4864
    ds_read_b32 v203, v211 offset:4992
    ds_read_b32 v204, v210 offset:6656
    ds_read_b32 v205, v210 offset:6784
    ds_read_b32 v206, v211 offset:6912
    ds_read_b32 v207, v211 offset:7040
L_nox_10:
    s_bitcmp1_b32 s8, 0
    s_cselect_b32 s38, s42, s40
    s_cselect_b32 s39, s43, s41
    s_lshl_b32 s14, s9, 1
    s_bfe_u32 s15, s8, 0x10001
    s_add_u32 s14, s14, s15
    s_mul_i32 s14, s14, 36864
    s_mul_i32 s15, s3, 36
    v_add_u32 v2, s15, v1
    v_and_b32 v3, 31, v2
    v_mul_u32_u24 v3, 1152, v3
    v_lshrrev_b32 v2, 5, v2
    v_lshl_add_u32 v2, v2, 7, v3
    v_add_u32 v2, s14, v2
    s_mov_b32 exec_hi, 15
    global_load_dword v251, v2, s[38:39]
    s_mov_b32 exec_hi, -1
    s_lshl_b32 s14, s11, 8
    v_lshl_add_u32 v10, v7, 3, s14
    v_lshlrev_b32 v11, 1, v10
    v_add_u32 v10, 151552, v10
    s_lshl_b32 s14, s10, 10
    v_lshl_add_u32 v9, v6, 9, v10
    v_add_u32 v9, s14, v9
    s_lshl_b32 s14, s9, 4
    s_add_u32 s14, s14, s8
    s_lshl_b32 s59, s14, 10
    s_add_u32 s59, s59, 4096
    s_lshl_b32 s70, s8, 7
    s_add_u32 s70, s70, 393216
    v_min_u32 v249, 8, v1
    v_lshlrev_b32 v249, 3, v249
    s_waitcnt lgkmcnt(4)
    v_mfma_f32_32x32x16_bf16 v[64:79], v[96:99], v[100:103], v[64:79]
    ds_read_b128 v[120:123], v22 offset:36864
    ds_read_b128 v[124:127], v30 offset:36864
    s_waitcnt lgkmcnt(5)
    v_mfma_f32_32x32x16_bf16 v[80:95], v[96:99], v[104:107], v[80:95]
    ds_read_b128 v[128:131], v30 offset:45056
    ds_read_b128 v[132:135], v23 offset:36864
    s_waitcnt lgkmcnt(5)
    v_mfma_f32_32x32x16_bf16 v[64:79], v[108:111], v[112:115], v[64:79]
    ds_read_b128 v[136:139], v31 offset:36864
    ds_read_b128 v[140:143], v31 offset:45056
    s_waitcnt lgkmcnt(6)
    v_mfma_f32_32x32x16_bf16 v[80:95], v[108:111], v[116:119], v[80:95]
    s_waitcnt vmcnt(5)
    v_readfirstlane_b32 s12, v245
    s_nop 0
    s_cmp_lg_u32 s12, 0
    s_cbranch_scc1 L_tagok_11
    s_mov_b32 s13, 200000
    v_mov_b32 v2, 0
L_tagspin_12:
    s_sleep 1
    global_load_dword v245, v2, s[54:55] sc1
    s_waitcnt vmcnt(0)
    v_readfirstlane_b32 s12, v245
    s_sub_u32 s13, s13, 1
    s_cbranch_scc1 L_tagok_11
    s_cmp_eq_u32 s12, 0
    s_cbranch_scc1 L_tagspin_12
L_tagok_11:
    v_mov_b32 v13, s12
    v_mov_b32 v15, s12
    s_lshl1_add_u32 s15, s9, s11
    s_lshl_b32 s15, s15, 2
    v_mov_b32 v252, s15
    v_mov_b32 v253, s12
    v_xor_b32 v2, 1, v6
    v_lshl_add_u32 v248, v2, 10, v11
    v_lshlrev_b32 v4, 4, v1
    s_cmp_lg_u32 s10, 0
    s_cbranch_scc1 L_nogi_13
    v_mov_b32 v32, 0
    v_mov_b32 v33, s12
    v_mov_b32 v34, 0
    v_mov_b32 v35, s12
    v_mov_b32 v36, 0
    v_mov_b32 v37, s12
    v_mov_b32 v38, 0
    v_mov_b32 v39, s12
    v_mov_b32 v40, 0
    v_mov_b32 v41, s12
    v_mov_b32 v42, 0
    v_mov_b32 v43, s12
    v_mov_b32 v44, 0
    v_mov_b32 v45, s12
    v_mov_b32 v46, 0
    v_mov_b32 v47, s12
    v_mov_b32 v48, 0
    v_mov_b32 v49, s12
    v_mov_b32 v50, 0
    v_mov_b32 v51, s12
    v_mov_b32 v52, 0
    v_mov_b32 v53, s12
    v_mov_b32 v54, 0
    v_mov_b32 v55, s12
    v_mov_b32 v56, 0
    v_mov_b32 v57, s12
    v_mov_b32 v58, 0
    v_mov_b32 v59, s12
    v_mov_b32 v60, 0
    v_mov_b32 v61, s12
    v_mov_b32 v62, 0
    v_mov_b32 v63, s12
L_nogi_13:
    s_waitcnt vmcnt(1) lgkmcnt(0)
    s_barrier
    v_mfma_f32_32x32x16_bf16 v[64:79], v[120:123], v[124:127], v[64:79]
    ds_read_b128 v[96:99], v16 offset:4096
    ds_read_b128 v[100:103], v24 offset:4096
    v_mfma_f32_32x32x16_bf16 v[80:95], v[120:123], v[128:131], v[80:95]
    ds_read_b128 v[104:107], v24 offset:12288
    ds_read_b128 v[108:111], v17 offset:4096
    v_mfma_f32_32x32x16_bf16 v[64:79], v[132:135], v[136:139], v[64:79]
    ds_read_b128 v[112:115], v25 offset:4096
    ds_read_b128 v[116:119], v25 offset:12288
    v_mfma_f32_32x32x16_bf16 v[80:95], v[132:135], v[140:143], v[80:95]
    s_cmp_lg_u32 s7, 8
    s_cbranch_scc1 L_nox_14
    ds_read_b32 v192, v208 offset:4096
    ds_read_b32 v193, v208 offset:4224
    ds_read_b32 v194, v209 offset:4352
    ds_read_b32 v195, v209 offset:4480
    ds_read_b32 v196, v208 offset:6144
    ds_read_b32 v197, v208 offset:6272
    ds_read_b32 v198, v209 offset:6400
    ds_read_b32 v199, v209 offset:6528
    ds_read_b32 v200, v210 offset:4608
    ds_read_b32 v201, v210 offset:4736
    ds_read_b32 v202, v211 offset:4864
    ds_read_b32 v203, v211 offset:4992
    ds_read_b32 v204, v210 offset:6656
    ds_read_b32 v205, v210 offset:6784
    ds_read_b32 v206, v211 offset:6912
    ds_read_b32 v207, v211 offset:7040
L_nox_14:
    s_waitcnt lgkmcnt(4)
    v_mfma_f32_32x32x16_bf16 v[64:79], v[96:99], v[100:103], v[64:79]
    ds_read_b128 v[120:123], v18 offset:4096
    ds_read_b128 v[124:127], v26 offset:4096
    s_waitcnt lgkmcnt(5)
    v_mfma_f32_32x32x16_bf16 v[80:95], v[96:99], v[104:107], v[80:95]
    ds_read_b128 v[128:131], v26 offset:12288
    ds_read_b128 v[132:135], v19 offset:4096
    s_waitcnt lgkmcnt(5)
    v_mfma_f32_32x32x16_bf16 v[64:79], v[108:111], v[112:115], v[64:79]
    ds_read_b128 v[136:139], v27 offset:4096
    ds_read_b128 v[140:143], v27 offset:12288
    s_waitcnt lgkmcnt(6)
    v_mfma_f32_32x32x16_bf16 v[80:95], v[108:111], v[116:119], v[80:95]
    s_waitcnt lgkmcnt(4)
    v_mfma_f32_32x32x16_bf16 v[64:79], v[120:123], v[124:127], v[64:79]
    s_waitcnt lgkmcnt(3)
    v_mfma_f32_32x32x16_bf16 v[80:95], v[120:123], v[128:131], v[80:95]
    s_waitcnt lgkmcnt(1)
    v_mfma_f32_32x32x16_bf16 v[64:79], v[132:135], v[136:139], v[64:79]
    s_waitcnt lgkmcnt(0)
    v_mfma_f32_32x32x16_bf16 v[80:95], v[132:135], v[140:143], v[80:95]
    s_nop 9
    v_fmac_f32 v65, v216, v64
    s_nop 0
    v_fmac_f32 v81, v216, v80
    v_fmac_f32 v65, v218, v80
    v_fmac_f32 v81, v217, v64
    v_fmac_f32 v66, v216, v65
    v_fmac_f32 v82, v216, v81
    v_fmac_f32 v66, v218, v81
    v_fmac_f32 v82, v217, v65
    v_fmac_f32 v67, v216, v66
    v_fmac_f32 v83, v216, v82
    v_fmac_f32 v67, v218, v82
    v_fmac_f32 v83, v217, v66
    v_fmac_f32 v68, v216, v67
    v_fmac_f32 v84, v216, v83
    v_fmac_f32 v68, v218, v83
    v_fmac_f32 v84, v217, v67
    v_fmac_f32 v69, v216, v68
    v_fmac_f32 v85, v216, v84
    v_fmac_f32 v69, v218, v84
    v_fmac_f32 v85, v217, v68
    v_fmac_f32 v70, v216, v69
    v_fmac_f32 v86, v216, v85
    v_fmac_f32 v70, v218, v85
    v_fmac_f32 v86, v217, v69
    v_fmac_f32 v71, v216, v70
    v_fmac_f32 v87, v216, v86
    v_fmac_f32 v71, v218, v86
    v_fmac_f32 v87, v217, v70
    v_fmac_f32 v72, v216, v71
    v_fmac_f32 v88, v216, v87
    v_fmac_f32 v72, v218, v87
    v_fmac_f32 v88, v217, v71
    v_fmac_f32 v73, v216, v72
    v_fmac_f32 v89, v216, v88
    v_fmac_f32 v73, v218, v88
    v_fmac_f32 v89, v217, v72
    v_fmac_f32 v74, v216, v73
    v_fmac_f32 v90, v216, v89
    v_fmac_f32 v74, v218, v89
    v_fmac_f32 v90, v217, v73
    v_fmac_f32 v75, v216, v74
    v_fmac_f32 v91, v216, v90
    v_fmac_f32 v75, v218, v90
    v_fmac_f32 v91, v217, v74
    v_fmac_f32 v76, v216, v75
    v_fmac_f32 v92, v216, v91
    v_fmac_f32 v76, v218, v91
    v_fmac_f32 v92, v217, v75
    v_fmac_f32 v77, v216, v76
    v_fmac_f32 v93, v216, v92
    v_fmac_f32 v77, v218, v92
    v_fmac_f32 v93, v217, v76
    v_fmac_f32 v78, v216, v77
    v_fmac_f32 v94, v216, v93
    v_fmac_f32 v78, v218, v93
    v_fmac_f32 v94, v217, v77
    v_fmac_f32 v79, v216, v78
    v_fmac_f32 v95, v216, v94
    v_fmac_f32 v79, v218, v94
    v_fmac_f32 v95, v217, v78
    ds_write2_b32 v9, v79, v95 offset0:0 offset1:1
    s_waitcnt lgkmcnt(0)
    s_barrier
    ds_read_b64 v[128:129], v10 offset:0
    ds_read_b64 v[130:131], v10 offset:512
    ds_read_b64 v[132:133], v10 offset:1024
    ds_read_b64 v[134:135], v10 offset:1536
    ds_read_b64 v[136:137], v10 offset:2048
    ds_read_b64 v[138:139], v10 offset:2560
    ds_read_b64 v[140:141], v10 offset:3072
    ds_read_b64 v[142:143], v10 offset:3584
    s_waitcnt lgkmcnt(6)
    v_pk_fma_f32 v[130:131], v[128:129], v[220:221], v[130:131] op_sel:[0,0,0] op_sel_hi:[0,1,1]
    v_pk_fma_f32 v[130:131], v[128:129], v[220:221], v[130:131] op_sel:[1,1,0] op_sel_hi:[1,0,1] neg_lo:[0,1,0]
    s_waitcnt lgkmcnt(5)
    v_pk_fma_f32 v[132:133], v[130:131], v[220:221], v[132:133] op_sel:[0,0,0] op_sel_hi:[0,1,1]
    v_pk_fma_f32 v[132:133], v[130:131], v[220:221], v[132:133] op_sel:[1,1,0] op_sel_hi:[1,0,1] neg_lo:[0,1,0]
    s_waitcnt lgkmcnt(4)
    v_pk_fma_f32 v[134:135], v[132:133], v[220:221], v[134:135] op_sel:[0,0,0] op_sel_hi:[0,1,1]
    v_pk_fma_f32 v[134:135], v[132:133], v[220:221], v[134:135] op_sel:[1,1,0] op_sel_hi:[1,0,1] neg_lo:[0,1,0]
    s_waitcnt lgkmcnt(3)
    v_pk_fma_f32 v[136:137], v[134:135], v[220:221], v[136:137] op_sel:[0,0,0] op_sel_hi:[0,1,1]
    v_pk_fma_f32 v[136:137], v[134:135], v[220:221], v[136:137] op_sel:[1,1,0] op_sel_hi:[1,0,1] neg_lo:[0,1,0]
    s_waitcnt lgkmcnt(2)
    v_pk_fma_f32 v[138:139], v[136:137], v[220:221], v[138:139] op_sel:[0,0,0] op_sel_hi:[0,1,1]
    v_pk_fma_f32 v[138:139], v[136:137], v[220:221], v[138:139] op_sel:[1,1,0] op_sel_hi:[1,0,1] neg_lo:[0,1,0]
    s_waitcnt lgkmcnt(1)
    v_pk_fma_f32 v[140:141], v[138:139], v[220:221], v[140:141] op_sel:[0,0,0] op_sel_hi:[0,1,1]
    v_pk_fma_f32 v[140:141], v[138:139], v[220:221], v[140:141] op_sel:[1,1,0] op_sel_hi:[1,0,1] neg_lo:[0,1,0]
    s_waitcnt lgkmcnt(0)
    v_pk_fma_f32 v[142:143], v[140:141], v[220:221], v[142:143] op_sel:[0,0,0] op_sel_hi:[0,1,1]
    v_pk_fma_f32 v[142:143], v[140:141], v[220:221], v[142:143] op_sel:[1,1,0] op_sel_hi:[1,0,1] neg_lo:[0,1,0]
    s_cmp_lg_u32 s10, 0
    s_cbranch_scc1 L_nopub_15
    v_mov_b32 v12, v142
    v_mov_b32 v14, v143
    s_mov_b32 exec_hi, 0
    buffer_store_dwordx4 v[12:15], v11, s[80:83], s59 offen sc1
    s_mov_b32 exec_hi, -1
L_nopub_15:
    s_mov_b32 vcc_lo, 0
    s_mov_b32 vcc_hi, -1
    v_add_u32 v245, 4096, v10
    s_cmp_eq_u32 s10, 0
    s_cbranch_scc1 L_poller_16
    s_cmp_lg_u32 s10, 1
    s_cbranch_scc1 L_pre_19
    v_cndmask_b32 v232, v130, v132, vcc
    v_cndmask_b32 v233, v131, v133, vcc
    s_branch L_pre_18
L_pre_19:
    s_cmp_lg_u32 s10, 2
    s_cbranch_scc1 L_pre_20
    v_cndmask_b32 v232, v134, v136, vcc
    v_cndmask_b32 v233, v135, v137, vcc
    s_branch L_pre_18
L_pre_20:
    v_cndmask_b32 v232, v138, v140, vcc
    v_cndmask_b32 v233, v139, v141, vcc
L_pre_18:
    s_cmp_eq_u32 s10, 1
    s_cbranch_scc1 L_c1_22
    s_add_u32 m0, s68, 36864
    s_add_u32 s66, s76, s26
    buffer_load_dwordx4 v246, s[72:75], s66 offen lds
    v_pk_mul_f32 v[238:239], v[64:65], v[222:223] op_sel:[0,0] op_sel_hi:[1,0]
    v_pk_fma_f32 v[238:239], v[80:81], v[222:223], v[238:239] op_sel:[0,1,0] op_sel_hi:[1,1,1] neg_lo:[0,1,0] neg_hi:[0,1,0]
    v_pk_mul_f32 v[80:81], v[80:81], v[222:223] op_sel:[0,0] op_sel_hi:[1,0]
    v_pk_fma_f32 v[80:81], v[64:65], v[222:223], v[80:81] op_sel:[0,1,0] op_sel_hi:[1,1,1]
    s_add_u32 m0, s68, 37888
    s_add_u32 s66, s77, s26
    buffer_load_dwordx4 v247, s[72:75], s66 offen lds
    v_pk_mov_b32 v[64:65], v[238:239], v[238:239] op_sel:[0,1]
    v_pk_mul_f32 v[238:239], v[66:67], v[222:223] op_sel:[0,0] op_sel_hi:[1,0]
    v_pk_fma_f32 v[238:239], v[82:83], v[222:223], v[238:239] op_sel:[0,1,0] op_sel_hi:[1,1,1] neg_lo:[0,1,0] neg_hi:[0,1,0]
    v_pk_mul_f32 v[82:83], v[82:83], v[222:223] op_sel:[0,0] op_sel_hi:[1,0]
    s_add_u32 m0, s68, 38912
    s_add_u32 s66, s78, s26
    buffer_load_dwordx4 v246, s[72:75], s66 offen lds
    v_pk_fma_f32 v[82:83], v[66:67], v[222:223], v[82:83] op_sel:[0,1,0] op_sel_hi:[1,1,1]
    v_pk_mov_b32 v[66:67], v[238:239], v[238:239] op_sel:[0,1]
    v_pk_mul_f32 v[238:239], v[68:69], v[222:223] op_sel:[0,0] op_sel_hi:[1,0]
    v_pk_fma_f32 v[238:239], v[84:85], v[222:223], v[238:239] op_sel:[0,1,0] op_sel_hi:[1,1,1] neg_lo:[0,1,0] neg_hi:[0,1,0]
    s_add_u32 m0, s68, 39936
    s_add_u32 s66, s79, s26
    buffer_load_dwordx4 v247, s[72:75], s66 offen lds
    v_pk_mul_f32 v[84:85], v[84:85], v[222:223] op_sel:[0,0] op_sel_hi:[1,0]
    v_pk_fma_f32 v[84:85], v[68:69], v[222:223], v[84:85] op_sel:[0,1,0] op_sel_hi:[1,1,1]
    v_pk_mov_b32 v[68:69], v[238:239], v[238:239] op_sel:[0,1]
    v_pk_mul_f32 v[238:239], v[70:71], v[222:223] op_sel:[0,0] op_sel_hi:[1,0]
    s_add_u32 m0, s68, 69632
    s_add_u32 s66, s76, s27
    buffer_load_dwordx4 v246, s[72:75], s66 offen lds
    v_pk_fma_f32 v[238:239], v[86:87], v[222:223], v[238:239] op_sel:[0,1,0] op_sel_hi:[1,1,1] neg_lo:[0,1,0] neg_hi:[0,1,0]
    v_pk_mul_f32 v[86:87], v[86:87], v[222:223] op_sel:[0,0] op_sel_hi:[1,0]
    v_pk_fma_f32 v[86:87], v[70:71], v[222:223], v[86:87] op_sel:[0,1,0] op_sel_hi:[1,1,1]
    v_pk_mov_b32 v[70:71], v[238:239], v[238:239] op_sel:[0,1]
    s_add_u32 m0, s68, 70656
    s_add_u32 s66, s77, s27
    buffer_load_dwordx4 v247, s[72:75], s66 offen lds
    v_pk_mul_f32 v[238:239], v[72:73], v[222:223] op_sel:[0,0] op_sel_hi:[1,0]
    v_pk_fma_f32 v[238:239], v[88:89], v[222:223], v[238:239] op_sel:[0,1,0] op_sel_hi:[1,1,1] neg_lo:[0,1,0] neg_hi:[0,1,0]
    v_pk_mul_f32 v[88:89], v[88:89], v[222:223] op_sel:[0,0] op_sel_hi:[1,0]
    v_pk_fma_f32 v[88:89], v[72:73], v[222:223], v[88:89] op_sel:[0,1,0] op_sel_hi:[1,1,1]
    s_add_u32 m0, s68, 71680
    s_add_u32 s66, s78, s27
    buffer_load_dwordx4 v246, s[72:75], s66 offen lds
    v_pk_mov_b32 v[72:73], v[238:239], v[238:239] op_sel:[0,1]
    v_pk_mul_f32 v[238:239], v[74:75], v[222:223] op_sel:[0,0] op_sel_hi:[1,0]
    v_pk_fma_f32 v[238:239], v[90:91], v[222:223], v[238:239] op_sel:[0,1,0] op_sel_hi:[1,1,1] neg_lo:[0,1,0] neg_hi:[0,1,0]
    v_pk_mul_f32 v[90:91], v[90:91], v[222:223] op_sel:[0,0] op_sel_hi:[1,0]
    s_add_u32 m0, s68, 72704
    s_add_u32 s66, s79, s27
    buffer_load_dwordx4 v247, s[72:75], s66 offen lds
    v_pk_fma_f32 v[90:91], v[74:75], v[222:223], v[90:91] op_sel:[0,1,0] op_sel_hi:[1,1,1]
    v_pk_mov_b32 v[74:75], v[238:239], v[238:239] op_sel:[0,1]
    v_pk_mul_f32 v[238:239], v[76:77], v[222:223] op_sel:[0,0] op_sel_hi:[1,0]
    v_pk_fma_f32 v[238:239], v[92:93], v[222:223], v[238:239] op_sel:[0,1,0] op_sel_hi:[1,1,1] neg_lo:[0,1,0] neg_hi:[0,1,0]
    v_pk_mul_f32 v[92:93], v[92:93], v[222:223] op_sel:[0,0] op_sel_hi:[1,0]
    v_pk_fma_f32 v[92:93], v[76:77], v[222:223], v[92:93] op_sel:[0,1,0] op_sel_hi:[1,1,1]
    v_pk_mov_b32 v[76:77], v[238:239], v[238:239] op_sel:[0,1]
    v_pk_mul_f32 v[238:239], v[78:79], v[222:223] op_sel:[0,0] op_sel_hi:[1,0]
    v_pk_fma_f32 v[238:239], v[94:95], v[222:223], v[238:239] op_sel:[0,1,0] op_sel_hi:[1,1,1] neg_lo:[0,1,0] neg_hi:[0,1,0]
    v_pk_mul_f32 v[94:95], v[94:95], v[222:223] op_sel:[0,0] op_sel_hi:[1,0]
    v_pk_fma_f32 v[94:95], v[78:79], v[222:223], v[94:95] op_sel:[0,1,0] op_sel_hi:[1,1,1]
    v_pk_mov_b32 v[78:79], v[238:239], v[238:239] op_sel:[0,1]
    s_branch L_join_17
L_c1_22:
    s_add_u32 m0, s68, 36864
    s_add_u32 s66, s76, s26
    buffer_load_dwordx4 v246, s[72:75], s66 offen lds
    v_pk_mul_f32 v[238:239], v[64:65], v[222:223] op_sel:[0,0] op_sel_hi:[1,0]
    v_pk_fma_f32 v[238:239], v[80:81], v[222:223], v[238:239] op_sel:[0,1,0] op_sel_hi:[1,1,1] neg_lo:[0,1,0] neg_hi:[0,1,0]
    s_add_u32 m0, s68, 37888
    s_add_u32 s66, s77, s26
    buffer_load_dwordx4 v247, s[72:75], s66 offen lds
    v_pk_mul_f32 v[80:81], v[80:81], v[222:223] op_sel:[0,0] op_sel_hi:[1,0]
    v_pk_fma_f32 v[80:81], v[64:65], v[222:223], v[80:81] op_sel:[0,1,0] op_sel_hi:[1,1,1]
    s_add_u32 m0, s68, 38912
    s_add_u32 s66, s78, s26
    buffer_load_dwordx4 v246, s[72:75], s66 offen lds
    v_pk_mov_b32 v[64:65], v[238:239], v[238:239] op_sel:[0,1]
    v_pk_mul_f32 v[238:239], v[66:67], v[222:223] op_sel:[0,0] op_sel_hi:[1,0]
    s_add_u32 m0, s68, 39936
    s_add_u32 s66, s79, s26
    buffer_load_dwordx4 v247, s[72:75], s66 offen lds
    v_pk_fma_f32 v[238:239], v[82:83], v[222:223], v[238:239] op_sel:[0,1,0] op_sel_hi:[1,1,1] neg_lo:[0,1,0] neg_hi:[0,1,0]
    v_pk_mul_f32 v[82:83], v[82:83], v[222:223] op_sel:[0,0] op_sel_hi:[1,0]
    s_add_u32 m0, s68, 69632
    s_add_u32 s66, s76, s27
    buffer_load_dwordx4 v246, s[72:75], s66 offen lds
    v_pk_fma_f32 v[82:83], v[66:67], v[222:223], v[82:83] op_sel:[0,1,0] op_sel_hi:[1,1,1]
    v_pk_mov_b32 v[66:67], v[238:239], v[238:239] op_sel:[0,1]
    s_add_u32 m0, s68, 70656
    s_add_u32 s66, s77, s27
    buffer_load_dwordx4 v247, s[72:75], s66 offen lds
    v_pk_mul_f32 v[238:239], v[68:69], v[222:223] op_sel:[0,0] op_sel_hi:[1,0]
    v_pk_fma_f32 v[238:239], v[84:85], v[222:223], v[238:239] op_sel:[0,1,0] op_sel_hi:[1,1,1] neg_lo:[0,1,0] neg_hi:[0,1,0]
    s_add_u32 m0, s68, 71680
    s_add_u32 s66, s78, s27
    buffer_load_dwordx4 v246, s[72:75], s66 offen lds
    v_pk_mul_f32 v[84:85], v[84:85], v[222:223] op_sel:[0,0] op_sel_hi:[1,0]
    v_pk_fma_f32 v[84:85], v[68:69], v[222:223], v[84:85] op_sel:[0,1,0] op_sel_hi:[1,1,1]
    s_add_u32 m0, s68, 72704
    s_add_u32 s66, s79, s27
    buffer_load_dwordx4 v247, s[72:75], s66 offen lds
    v_pk_mov_b32 v[68:69], v[238:239], v[238:239] op_sel:[0,1]
    v_pk_mul_f32 v[238:239], v[70:71], v[222:223] op_sel:[0,0] op_sel_hi:[1,0]
    s_add_u32 m0, s68, 32768
    s_add_u32 s66, s76, s26
    s_sub_u32 s66, s66, 1152
    buffer_load_dwordx4 v246, s[72:75], s66 offen lds
    v_pk_fma_f32 v[238:239], v[86:87], v[222:223], v[238:239] op_sel:[0,1,0] op_sel_hi:[1,1,1] neg_lo:[0,1,0] neg_hi:[0,1,0]
    v_pk_mul_f32 v[86:87], v[86:87], v[222:223] op_sel:[0,0] op_sel_hi:[1,0]
    s_add_u32 m0, s68, 33792
    s_add_u32 s66, s77, s26
    s_sub_u32 s66, s66, 1152
    buffer_load_dwordx4 v247, s[72:75], s66 offen lds
    v_pk_fma_f32 v[86:87], v[70:71], v[222:223], v[86:87] op_sel:[0,1,0] op_sel_hi:[1,1,1]
    v_pk_mov_b32 v[70:71], v[238:239], v[238:239] op_sel:[0,1]
    s_add_u32 m0, s68, 34816
    s_add_u32 s66, s78, s26
    s_sub_u32 s66, s66, 1152
    buffer_load_dwordx4 v246, s[72:75], s66 offen lds
    v_pk_mul_f32 v[238:239], v[72:73], v[222:223] op_sel:[0,0] op_sel_hi:[1,0]
    v_pk_fma_f32 v[238:239], v[88:89], v[222:223], v[238:239] op_sel:[0,1,0] op_sel_hi:[1,1,1] neg_lo:[0,1,0] neg_hi:[0,1,0]
    s_add_u32 m0, s68, 35840
    s_add_u32 s66, s79, s26
    s_sub_u32 s66, s66, 1152
    buffer_load_dwordx4 v247, s[72:75], s66 offen lds
    v_pk_mul_f32 v[88:89], v[88:89], v[222:223] op_sel:[0,0] op_sel_hi:[1,0]
    v_pk_fma_f32 v[88:89], v[72:73], v[222:223], v[88:89] op_sel:[0,1,0] op_sel_hi:[1,1,1]
    s_add_u32 m0, s68, 65536
    s_add_u32 s66, s76, s27
    s_sub_u32 s66, s66, 1152
    buffer_load_dwordx4 v246, s[72:75], s66 offen lds
    v_pk_mov_b32 v[72:73], v[238:239], v[238:239] op_sel:[0,1]
    v_pk_mul_f32 v[238:239], v[74:75], v[222:223] op_sel:[0,0] op_sel_hi:[1,0]
    s_add_u32 m0, s68, 66560
    s_add_u32 s66, s77, s27
    s_sub_u32 s66, s66, 1152
    buffer_load_dwordx4 v247, s[72:75], s66 offen lds
    v_pk_fma_f32 v[238:239], v[90:91], v[222:223], v[238:239] op_sel:[0,1,0] op_sel_hi:[1,1,1] neg_lo:[0,1,0] neg_hi:[0,1,0]
    v_pk_mul_f32 v[90:91], v[90:91], v[222:223] op_sel:[0,0] op_sel_hi:[1,0]
    s_add_u32 m0, s68, 67584
    s_add_u32 s66, s78, s27
    s_sub_u32 s66, s66, 1152
    buffer_load_dwordx4 v246, s[72:75], s66 offen lds
    v_pk_fma_f32 v[90:91], v[74:75], v[222:223], v[90:91] op_sel:[0,1,0] op_sel_hi:[1,1,1]
    v_pk_mov_b32 v[74:75], v[238:239], v[238:239] op_sel:[0,1]
    s_add_u32 m0, s68, 68608
    s_add_u32 s66, s79, s27
    s_sub_u32 s66, s66, 1152
    buffer_load_dwordx4 v247, s[72:75], s66 offen lds
    v_pk_mul_f32 v[238:239], v[76:77], v[222:223] op_sel:[0,0] op_sel_hi:[1,0]
    v_pk_fma_f32 v[238:239], v[92:93], v[222:223], v[238:239] op_sel:[0,1,0] op_sel_hi:[1,1,1] neg_lo:[0,1,0] neg_hi:[0,1,0]
    v_pk_mul_f32 v[92:93], v[92:93], v[222:223] op_sel:[0,0] op_sel_hi:[1,0]
    v_pk_fma_f32 v[92:93], v[76:77], v[222:223], v[92:93] op_sel:[0,1,0] op_sel_hi:[1,1,1]
    v_pk_mov_b32 v[76:77], v[238:239], v[238:239] op_sel:[0,1]
    v_pk_mul_f32 v[238:239], v[78:79], v[222:223] op_sel:[0,0] op_sel_hi:[1,0]
    v_pk_fma_f32 v[238:239], v[94:95], v[222:223], v[238:239] op_sel:[0,1,0] op_sel_hi:[1,1,1] neg_lo:[0,1,0] neg_hi:[0,1,0]
    v_pk_mul_f32 v[94:95], v[94:95], v[222:223] op_sel:[0,0] op_sel_hi:[1,0]
    v_pk_fma_f32 v[94:95], v[78:79], v[222:223], v[94:95] op_sel:[0,1,0] op_sel_hi:[1,1,1]
    v_pk_mov_b32 v[78:79], v[238:239], v[238:239] op_sel:[0,1]
    s_branch L_join_17
L_poller_16:
    v_cndmask_b32 v232, 0, v128, vcc
    v_cndmask_b32 v233, 0, v129, vcc
    s_cmp_le_u32 s8, 0
    s_cbranch_scc1 L_aggdone_23
    s_cmp_eq_u32 s8, 1
    s_cselect_b32 exec_hi, 0, -1
    s_sub_u32 s14, s59, 2048
    buffer_load_dwordx4 v[32:35], v248, s[80:83], s14 offen sc1
    s_cmp_le_u32 s8, 2
    s_cbranch_scc1 L_aggdone_23
    s_cmp_eq_u32 s8, 3
    s_cselect_b32 exec_hi, 0, -1
    s_sub_u32 s14, s59, 4096
    buffer_load_dwordx4 v[36:39], v248, s[80:83], s14 offen sc1
    s_cmp_le_u32 s8, 4
    s_cbranch_scc1 L_aggdone_23
    s_cmp_eq_u32 s8, 5
    s_cselect_b32 exec_hi, 0, -1
    s_sub_u32 s14, s59, 6144
    buffer_load_dwordx4 v[40:43], v248, s[80:83], s14 offen sc1
    s_cmp_le_u32 s8, 6
    s_cbranch_scc1 L_aggdone_23
    s_cmp_eq_u32 s8, 7
    s_cselect_b32 exec_hi, 0, -1
    s_sub_u32 s14, s59, 8192
    buffer_load_dwordx4 v[44:47], v248, s[80:83], s14 offen sc1
    s_cmp_le_u32 s8, 8
    s_cbranch_scc1 L_aggdone_23
    s_cmp_eq_u32 s8, 9
    s_cselect_b32 exec_hi, 0, -1
    s_sub_u32 s14, s59, 10240
    buffer_load_dwordx4 v[48:51], v248, s[80:83], s14 offen sc1
    s_cmp_le_u32 s8, 10
    s_cbranch_scc1 L_aggdone_23
    s_cmp_eq_u32 s8, 11
    s_cselect_b32 exec_hi, 0, -1
    s_sub_u32 s14, s59, 12288
    buffer_load_dwordx4 v[52:55], v248, s[80:83], s14 offen sc1
    s_cmp_le_u32 s8, 12
    s_cbranch_scc1 L_aggdone_23
    s_cmp_eq_u32 s8, 13
    s_cselect_b32 exec_hi, 0, -1
    s_sub_u32 s14, s59, 14336
    buffer_load_dwordx4 v[56:59], v248, s[80:83], s14 offen sc1
    s_cmp_le_u32 s8, 14
    s_cbranch_scc1 L_aggdone_23
    s_cmp_eq_u32 s8, 15
    s_cselect_b32 exec_hi, 0, -1
    s_sub_u32 s14, s59, 16384
    buffer_load_dwordx4 v[60:63], v248, s[80:83], s14 offen sc1
L_aggdone_23:
    s_mov_b32 exec_hi, -1
    v_pk_mul_f32 v[238:239], v[64:65], v[222:223] op_sel:[0,0] op_sel_hi:[1,0]
    v_pk_fma_f32 v[238:239], v[80:81], v[222:223], v[238:239] op_sel:[0,1,0] op_sel_hi:[1,1,1] neg_lo:[0,1,0] neg_hi:[0,1,0]
    v_pk_mul_f32 v[80:81], v[80:81], v[222:223] op_sel:[0,0] op_sel_hi:[1,0]
    v_pk_fma_f32 v[80:81], v[64:65], v[222:223], v[80:81] op_sel:[0,1,0] op_sel_hi:[1,1,1]
    v_pk_mov_b32 v[64:65], v[238:239], v[238:239] op_sel:[0,1]
    v_pk_mul_f32 v[238:239], v[66:67], v[222:223] op_sel:[0,0] op_sel_hi:[1,0]
    v_pk_fma_f32 v[238:239], v[82:83], v[222:223], v[238:239] op_sel:[0,1,0] op_sel_hi:[1,1,1] neg_lo:[0,1,0] neg_hi:[0,1,0]
    v_pk_mul_f32 v[82:83], v[82:83], v[222:223] op_sel:[0,0] op_sel_hi:[1,0]
    v_pk_fma_f32 v[82:83], v[66:67], v[222:223], v[82:83] op_sel:[0,1,0] op_sel_hi:[1,1,1]
    v_pk_mov_b32 v[66:67], v[238:239], v[238:239] op_sel:[0,1]
    v_pk_mul_f32 v[238:239], v[68:69], v[222:223] op_sel:[0,0] op_sel_hi:[1,0]
    v_pk_fma_f32 v[238:239], v[84:85], v[222:223], v[238:239] op_sel:[0,1,0] op_sel_hi:[1,1,1] neg_lo:[0,1,0] neg_hi:[0,1,0]
    v_pk_mul_f32 v[84:85], v[84:85], v[222:223] op_sel:[0,0] op_sel_hi:[1,0]
    v_pk_fma_f32 v[84:85], v[68:69], v[222:223], v[84:85] op_sel:[0,1,0] op_sel_hi:[1,1,1]
    v_pk_mov_b32 v[68:69], v[238:239], v[238:239] op_sel:[0,1]
    v_pk_mul_f32 v[238:239], v[70:71], v[222:223] op_sel:[0,0] op_sel_hi:[1,0]
    v_pk_fma_f32 v[238:239], v[86:87], v[222:223], v[238:239] op_sel:[0,1,0] op_sel_hi:[1,1,1] neg_lo:[0,1,0] neg_hi:[0,1,0]
    v_pk_mul_f32 v[86:87], v[86:87], v[222:223] op_sel:[0,0] op_sel_hi:[1,0]
    v_pk_fma_f32 v[86:87], v[70:71], v[222:223], v[86:87] op_sel:[0,1,0] op_sel_hi:[1,1,1]
    v_pk_mov_b32 v[70:71], v[238:239], v[238:239] op_sel:[0,1]
    v_pk_mul_f32 v[238:239], v[72:73], v[222:223] op_sel:[0,0] op_sel_hi:[1,0]
    v_pk_fma_f32 v[238:239], v[88:89], v[222:223], v[238:239] op_sel:[0,1,0] op_sel_hi:[1,1,1] neg_lo:[0,1,0] neg_hi:[0,1,0]
    v_pk_mul_f32 v[88:89], v[88:89], v[222:223] op_sel:[0,0] op_sel_hi:[1,0]
    v_pk_fma_f32 v[88:89], v[72:73], v[222:223], v[88:89] op_sel:[0,1,0] op_sel_hi:[1,1,1]
    v_pk_mov_b32 v[72:73], v[238:239], v[238:239] op_sel:[0,1]
    v_pk_mul_f32 v[238:239], v[74:75], v[222:223] op_sel:[0,0] op_sel_hi:[1,0]
    v_pk_fma_f32 v[238:239], v[90:91], v[222:223], v[238:239] op_sel:[0,1,0] op_sel_hi:[1,1,1] neg_lo:[0,1,0] neg_hi:[0,1,0]
    v_pk_mul_f32 v[90:91], v[90:91], v[222:223] op_sel:[0,0] op_sel_hi:[1,0]
    v_pk_fma_f32 v[90:91], v[74:75], v[222:223], v[90:91] op_sel:[0,1,0] op_sel_hi:[1,1,1]
    v_pk_mov_b32 v[74:75], v[238:239], v[238:239] op_sel:[0,1]
    v_pk_mul_f32 v[238:239], v[76:77], v[222:223] op_sel:[0,0] op_sel_hi:[1,0]
    v_pk_fma_f32 v[238:239], v[92:93], v[222:223], v[238:239] op_sel:[0,1,0] op_sel_hi:[1,1,1] neg_lo:[0,1,0] neg_hi:[0,1,0]
    v_pk_mul_f32 v[92:93], v[92:93], v[222:223] op_sel:[0,0] op_sel_hi:[1,0]
    v_pk_fma_f32 v[92:93], v[76:77], v[222:223], v[92:93] op_sel:[0,1,0] op_sel_hi:[1,1,1]
    v_pk_mov_b32 v[76:77], v[238:239], v[238:239] op_sel:[0,1]
    v_pk_mul_f32 v[238:239], v[78:79], v[222:223] op_sel:[0,0] op_sel_hi:[1,0]
    v_pk_fma_f32 v[238:239], v[94:95], v[222:223], v[238:239] op_sel:[0,1,0] op_sel_hi:[1,1,1] neg_lo:[0,1,0] neg_hi:[0,1,0]
    v_pk_mul_f32 v[94:95], v[94:95], v[222:223] op_sel:[0,0] op_sel_hi:[1,0]
    v_pk_fma_f32 v[94:95], v[78:79], v[222:223], v[94:95] op_sel:[0,1,0] op_sel_hi:[1,1,1]
    v_pk_mov_b32 v[78:79], v[238:239], v[238:239] op_sel:[0,1]
    s_mov_b32 s13, 200000
L_aggpoll_24:
    s_waitcnt vmcnt(0)
    v_xor_b32 v2, s12, v33
    v_bitop3_b32 v2, v2, v35, s12 bitop3:0xf6
    v_bitop3_b32 v2, v2, v37, s12 bitop3:0xf6
    v_bitop3_b32 v2, v2, v39, s12 bitop3:0xf6
    v_bitop3_b32 v2, v2, v41, s12 bitop3:0xf6
    v_bitop3_b32 v2, v2, v43, s12 bitop3:0xf6
    v_bitop3_b32 v2, v2, v45, s12 bitop3:0xf6
    v_bitop3_b32 v2, v2, v47, s12 bitop3:0xf6
    v_bitop3_b32 v2, v2, v49, s12 bitop3:0xf6
    v_bitop3_b32 v2, v2, v51, s12 bitop3:0xf6
    v_bitop3_b32 v2, v2, v53, s12 bitop3:0xf6
    v_bitop3_b32 v2, v2, v55, s12 bitop3:0xf6
    v_bitop3_b32 v2, v2, v57, s12 bitop3:0xf6
    v_bitop3_b32 v2, v2, v59, s12 bitop3:0xf6
    v_bitop3_b32 v2, v2, v61, s12 bitop3:0xf6
    v_bitop3_b32 v2, v2, v63, s12 bitop3:0xf6
    v_cmp_ne_u32 vcc, 0, v2
    s_nop 4
    s_cbranch_vccz L_aggok_25
    s_sub_u32 s13, s13, 1
    s_cbranch_scc1 L_aggok_25
    s_cmp_le_u32 s8, 0
    s_cbranch_scc1 L_aggdone_26
    s_cmp_eq_u32 s8, 1
    s_cselect_b32 exec_hi, 0, -1
    s_sub_u32 s14, s59, 2048
    buffer_load_dwordx4 v[32:35], v248, s[80:83], s14 offen sc1
    s_cmp_le_u32 s8, 2
    s_cbranch_scc1 L_aggdone_26
    s_cmp_eq_u32 s8, 3
    s_cselect_b32 exec_hi, 0, -1
    s_sub_u32 s14, s59, 4096
    buffer_load_dwordx4 v[36:39], v248, s[80:83], s14 offen sc1
    s_cmp_le_u32 s8, 4
    s_cbranch_scc1 L_aggdone_26
    s_cmp_eq_u32 s8, 5
    s_cselect_b32 exec_hi, 0, -1
    s_sub_u32 s14, s59, 6144
    buffer_load_dwordx4 v[40:43], v248, s[80:83], s14 offen sc1
    s_cmp_le_u32 s8, 6
    s_cbranch_scc1 L_aggdone_26
    s_cmp_eq_u32 s8, 7
    s_cselect_b32 exec_hi, 0, -1
    s_sub_u32 s14, s59, 8192
    buffer_load_dwordx4 v[44:47], v248, s[80:83], s14 offen sc1
    s_cmp_le_u32 s8, 8
    s_cbranch_scc1 L_aggdone_26
    s_cmp_eq_u32 s8, 9
    s_cselect_b32 exec_hi, 0, -1
    s_sub_u32 s14, s59, 10240
    buffer_load_dwordx4 v[48:51], v248, s[80:83], s14 offen sc1
    s_cmp_le_u32 s8, 10
    s_cbranch_scc1 L_aggdone_26
    s_cmp_eq_u32 s8, 11
    s_cselect_b32 exec_hi, 0, -1
    s_sub_u32 s14, s59, 12288
    buffer_load_dwordx4 v[52:55], v248, s[80:83], s14 offen sc1
    s_cmp_le_u32 s8, 12
    s_cbranch_scc1 L_aggdone_26
    s_cmp_eq_u32 s8, 13
    s_cselect_b32 exec_hi, 0, -1
    s_sub_u32 s14, s59, 14336
    buffer_load_dwordx4 v[56:59], v248, s[80:83], s14 offen sc1
    s_cmp_le_u32 s8, 14
    s_cbranch_scc1 L_aggdone_26
    s_cmp_eq_u32 s8, 15
    s_cselect_b32 exec_hi, 0, -1
    s_sub_u32 s14, s59, 16384
    buffer_load_dwordx4 v[60:63], v248, s[80:83], s14 offen sc1
L_aggdone_26:
    s_mov_b32 exec_hi, -1
    s_branch L_aggpoll_24
L_aggok_25:
    v_pk_mul_f32 v[12:13], v[32:33], v[176:177] op_sel:[0,0] op_sel_hi:[0,1]
    v_pk_fma_f32 v[12:13], v[34:35], v[176:177], v[12:13] op_sel:[0,1,0] op_sel_hi:[0,0,1] neg_lo:[0,1,0]
    v_pk_mul_f32 v[14:15], v[36:37], v[178:179] op_sel:[0,0] op_sel_hi:[0,1]
    v_pk_fma_f32 v[14:15], v[38:39], v[178:179], v[14:15] op_sel:[0,1,0] op_sel_hi:[0,0,1] neg_lo:[0,1,0]
    v_pk_fma_f32 v[12:13], v[40:41], v[180:181], v[12:13] op_sel:[0,0,0] op_sel_hi:[0,1,1]
    v_pk_fma_f32 v[12:13], v[42:43], v[180:181], v[12:13] op_sel:[0,1,0] op_sel_hi:[0,0,1] neg_lo:[0,1,0]
    v_pk_fma_f32 v[14:15], v[44:45], v[182:183], v[14:15] op_sel:[0,0,0] op_sel_hi:[0,1,1]
    v_pk_fma_f32 v[14:15], v[46:47], v[182:183], v[14:15] op_sel:[0,1,0] op_sel_hi:[0,0,1] neg_lo:[0,1,0]
    v_pk_fma_f32 v[12:13], v[48:49], v[184:185], v[12:13] op_sel:[0,0,0] op_sel_hi:[0,1,1]
    v_pk_fma_f32 v[12:13], v[50:51], v[184:185], v[12:13] op_sel:[0,1,0] op_sel_hi:[0,0,1] neg_lo:[0,1,0]
    v_pk_fma_f32 v[14:15], v[52:53], v[186:187], v[14:15] op_sel:[0,0,0] op_sel_hi:[0,1,1]
    v_pk_fma_f32 v[14:15], v[54:55], v[186:187], v[14:15] op_sel:[0,1,0] op_sel_hi:[0,0,1] neg_lo:[0,1,0]
    v_pk_fma_f32 v[12:13], v[56:57], v[188:189], v[12:13] op_sel:[0,0,0] op_sel_hi:[0,1,1]
    v_pk_fma_f32 v[12:13], v[58:59], v[188:189], v[12:13] op_sel:[0,1,0] op_sel_hi:[0,0,1] neg_lo:[0,1,0]
    v_pk_fma_f32 v[14:15], v[60:61], v[190:191], v[14:15] op_sel:[0,0,0] op_sel_hi:[0,1,1]
    v_pk_fma_f32 v[14:15], v[62:63], v[190:191], v[14:15] op_sel:[0,1,0] op_sel_hi:[0,0,1] neg_lo:[0,1,0]
    v_pk_add_f32 v[12:13], v[12:13], v[14:15]
    v_pk_mov_b32 v[14:15], v[12:13], v[12:13] op_sel:[0,1]
    s_nop 1
    v_permlane32_swap_b32 v12, v14
    v_permlane32_swap_b32 v13, v15
    v_pk_add_f32 v[12:13], v[12:13], v[14:15]
    ds_write_b64 v245, v[12:13]
    s_waitcnt lgkmcnt(0)
L_join_17:
    s_barrier
    ds_read_b64 v[12:13], v245
    s_waitcnt lgkmcnt(0)
    v_pk_fma_f32 v[232:233], v[12:13], v[230:231], v[232:233] op_sel:[0,0,0] op_sel_hi:[0,1,1]
    v_pk_fma_f32 v[232:233], v[12:13], v[230:231], v[232:233] op_sel:[1,1,0] op_sel_hi:[1,0,1] neg_lo:[0,1,0]
    v_pk_fma_f32 v[64:65], v[144:145], v[232:233], v[64:65] op_sel:[0,0,0] op_sel_hi:[1,0,1]
    v_pk_fma_f32 v[80:81], v[144:145], v[232:233], v[80:81] op_sel:[0,1,0] op_sel_hi:[1,1,1]
    v_pk_fma_f32 v[64:65], v[160:161], v[232:233], v[64:65] op_sel:[0,1,0] op_sel_hi:[1,1,1] neg_lo:[0,1,0] neg_hi:[0,1,0]
    v_pk_fma_f32 v[80:81], v[160:161], v[232:233], v[80:81] op_sel:[0,0,0] op_sel_hi:[1,0,1]
    v_cvt_pk_bf16_f32 v96, v64, v65
    v_cvt_pk_bf16_f32 v104, -v80, -v81
    v_pk_fma_f32 v[66:67], v[146:147], v[232:233], v[66:67] op_sel:[0,0,0] op_sel_hi:[1,0,1]
    v_pk_fma_f32 v[82:83], v[146:147], v[232:233], v[82:83] op_sel:[0,1,0] op_sel_hi:[1,1,1]
    v_pk_fma_f32 v[66:67], v[162:163], v[232:233], v[66:67] op_sel:[0,1,0] op_sel_hi:[1,1,1] neg_lo:[0,1,0] neg_hi:[0,1,0]
    v_pk_fma_f32 v[82:83], v[162:163], v[232:233], v[82:83] op_sel:[0,0,0] op_sel_hi:[1,0,1]
    v_cvt_pk_bf16_f32 v97, v66, v67
    v_cvt_pk_bf16_f32 v105, -v82, -v83
    v_pk_fma_f32 v[68:69], v[148:149], v[232:233], v[68:69] op_sel:[0,0,0] op_sel_hi:[1,0,1]
    v_pk_fma_f32 v[84:85], v[148:149], v[232:233], v[84:85] op_sel:[0,1,0] op_sel_hi:[1,1,1]
    v_pk_fma_f32 v[68:69], v[164:165], v[232:233], v[68:69] op_sel:[0,1,0] op_sel_hi:[1,1,1] neg_lo:[0,1,0] neg_hi:[0,1,0]
    v_pk_fma_f32 v[84:85], v[164:165], v[232:233], v[84:85] op_sel:[0,0,0] op_sel_hi:[1,0,1]
    v_cvt_pk_bf16_f32 v98, v68, v69
    v_cvt_pk_bf16_f32 v106, -v84, -v85
    v_pk_fma_f32 v[70:71], v[150:151], v[232:233], v[70:71] op_sel:[0,0,0] op_sel_hi:[1,0,1]
    v_pk_fma_f32 v[86:87], v[150:151], v[232:233], v[86:87] op_sel:[0,1,0] op_sel_hi:[1,1,1]
    v_pk_fma_f32 v[70:71], v[166:167], v[232:233], v[70:71] op_sel:[0,1,0] op_sel_hi:[1,1,1] neg_lo:[0,1,0] neg_hi:[0,1,0]
    v_pk_fma_f32 v[86:87], v[166:167], v[232:233], v[86:87] op_sel:[0,0,0] op_sel_hi:[1,0,1]
    v_cvt_pk_bf16_f32 v99, v70, v71
    v_cvt_pk_bf16_f32 v107, -v86, -v87
    ds_write_b128 v212, v[96:99]
    ds_write_b128 v212, v[104:107] offset:2048
    v_pk_fma_f32 v[72:73], v[152:153], v[232:233], v[72:73] op_sel:[0,0,0] op_sel_hi:[1,0,1]
    v_pk_fma_f32 v[88:89], v[152:153], v[232:233], v[88:89] op_sel:[0,1,0] op_sel_hi:[1,1,1]
    v_pk_fma_f32 v[72:73], v[168:169], v[232:233], v[72:73] op_sel:[0,1,0] op_sel_hi:[1,1,1] neg_lo:[0,1,0] neg_hi:[0,1,0]
    v_pk_fma_f32 v[88:89], v[168:169], v[232:233], v[88:89] op_sel:[0,0,0] op_sel_hi:[1,0,1]
    v_cvt_pk_bf16_f32 v100, v72, v73
    v_cvt_pk_bf16_f32 v108, -v88, -v89
    v_pk_fma_f32 v[74:75], v[154:155], v[232:233], v[74:75] op_sel:[0,0,0] op_sel_hi:[1,0,1]
    v_pk_fma_f32 v[90:91], v[154:155], v[232:233], v[90:91] op_sel:[0,1,0] op_sel_hi:[1,1,1]
    v_pk_fma_f32 v[74:75], v[170:171], v[232:233], v[74:75] op_sel:[0,1,0] op_sel_hi:[1,1,1] neg_lo:[0,1,0] neg_hi:[0,1,0]
    v_pk_fma_f32 v[90:91], v[170:171], v[232:233], v[90:91] op_sel:[0,0,0] op_sel_hi:[1,0,1]
    v_cvt_pk_bf16_f32 v101, v74, v75
    v_cvt_pk_bf16_f32 v109, -v90, -v91
    v_pk_fma_f32 v[76:77], v[156:157], v[232:233], v[76:77] op_sel:[0,0,0] op_sel_hi:[1,0,1]
    v_pk_fma_f32 v[92:93], v[156:157], v[232:233], v[92:93] op_sel:[0,1,0] op_sel_hi:[1,1,1]
    v_pk_fma_f32 v[76:77], v[172:173], v[232:233], v[76:77] op_sel:[0,1,0] op_sel_hi:[1,1,1] neg_lo:[0,1,0] neg_hi:[0,1,0]
    v_pk_fma_f32 v[92:93], v[172:173], v[232:233], v[92:93] op_sel:[0,0,0] op_sel_hi:[1,0,1]
    v_cvt_pk_bf16_f32 v102, v76, v77
    v_cvt_pk_bf16_f32 v110, -v92, -v93
    v_pk_fma_f32 v[78:79], v[158:159], v[232:233], v[78:79] op_sel:[0,0,0] op_sel_hi:[1,0,1]
    v_pk_fma_f32 v[94:95], v[158:159], v[232:233], v[94:95] op_sel:[0,1,0] op_sel_hi:[1,1,1]
    v_pk_fma_f32 v[78:79], v[174:175], v[232:233], v[78:79] op_sel:[0,1,0] op_sel_hi:[1,1,1] neg_lo:[0,1,0] neg_hi:[0,1,0]
    v_pk_fma_f32 v[94:95], v[174:175], v[232:233], v[94:95] op_sel:[0,0,0] op_sel_hi:[1,0,1]
    v_cvt_pk_bf16_f32 v103, v78, v79
    v_cvt_pk_bf16_f32 v111, -v94, -v95
    ds_write_b128 v213, v[100:103]
    ds_write_b128 v213, v[108:111] offset:2048
    ds_read_b64_tr_b16 v[128:129], v214 offset:0
    ds_read_b64_tr_b16 v[130:131], v215 offset:256
    ds_read_b64_tr_b16 v[132:133], v214 offset:512
    ds_read_b64_tr_b16 v[134:135], v215 offset:768
    ds_read_b64_tr_b16 v[136:137], v214 offset:1024
    ds_read_b64_tr_b16 v[138:139], v215 offset:1280
    ds_read_b64_tr_b16 v[140:141], v214 offset:1536
    ds_read_b64_tr_b16 v[142:143], v215 offset:1792
    s_waitcnt lgkmcnt(6)
    buffer_store_dwordx4 v[128:131], v4, s[80:83], s6 offen offset:0 sc1
    s_waitcnt lgkmcnt(4)
    buffer_store_dwordx4 v[132:135], v4, s[80:83], s6 offen offset:1024 sc1
    s_waitcnt lgkmcnt(2)
    buffer_store_dwordx4 v[136:139], v4, s[80:83], s6 offen offset:2048 sc1
    s_waitcnt lgkmcnt(0)
    buffer_store_dwordx4 v[140:143], v4, s[80:83], s6 offen offset:3072 sc1
    s_barrier
    s_cmp_lg_u32 s11, 0
    s_cbranch_scc1 L_nosetup_27
    ds_read_b64_tr_b16 v[144:145], v214 offset:16384
    ds_read_b64_tr_b16 v[146:147], v215 offset:16640
    ds_read_b64_tr_b16 v[148:149], v214 offset:16896
    ds_read_b64_tr_b16 v[150:151], v215 offset:17152
    ds_read_b64_tr_b16 v[152:153], v214 offset:17408
    ds_read_b64_tr_b16 v[154:155], v215 offset:17664
    ds_read_b64_tr_b16 v[156:157], v214 offset:17920
    ds_read_b64_tr_b16 v[158:159], v215 offset:18176
    s_lshl_b32 s16, s16, 6
    s_add_u32 s16, s16, s58
    s_lshl_b32 s17, s17, 6
    s_add_u32 s17, s17, s58
    s_lshl_b32 s18, s18, 6
    s_add_u32 s18, s18, s58
    s_lshl_b32 s19, s19, 6
    s_add_u32 s19, s19, s58
    s_lshl_b32 s20, s20, 6
    s_add_u32 s20, s20, s58
    s_lshl_b32 s21, s21, 6
    s_add_u32 s21, s21, s58
    s_lshl_b32 s22, s22, 6
    s_add_u32 s22, s22, s58
    s_lshl_b32 s23, s23, 6
    s_add_u32 s23, s23, s58
    s_lshl_b32 s24, s24, 6
    s_add_u32 s24, s24, s58
    v_lshrrev_b32 v2, 1, v7
    v_and_b32 v2, 7, v2
    v_lshlrev_b32 v2, 4, v2
    v_lshl_add_u32 v2, v7, 7, v2
    v_lshl_add_u32 v2, v6, 13, v2
    v_add_u32 v2, 32768, v2
    v_xor_b32 v16, 0, v2
    v_xor_b32 v17, 16, v2
    v_xor_b32 v18, 32, v2
    v_xor_b32 v19, 48, v2
    v_xor_b32 v20, 64, v2
    v_xor_b32 v21, 80, v2
    v_xor_b32 v22, 96, v2
    v_xor_b32 v23, 112, v2
    s_lshl_b32 s14, s8, 7
    s_lshl_b32 s15, s10, 5
    s_add_u32 s14, s14, s15
    s_mul_i32 s14, s14, 4608
    s_lshl_b32 s15, s9, 8
    s_add_u32 s14, s14, s15
    s_add_u32 s14, s14, 2304
    v_mul_u32_u24 v2, 18432, v6
    v_lshl_add_u32 v9, v7, 3, v2
    v_min_u32 v2, 17, v1
    v_lshlrev_b32 v2, 2, v2
    s_mov_b32 s13, 200000
    v_and_b32 v11, 0xffff0000, v243
    v_lshlrev_b32 v10, 16, v243
    v_lshlrev_b32 v12, 16, v192
    v_and_b32 v13, 0xffff0000, v192
    v_pk_mul_f32 v[12:13], v[12:13], v[10:11]
    v_cvt_pk_bf16_f32 v192, v12, v13
    v_lshlrev_b32 v32, 16, v192
    v_and_b32 v48, 0xffff0000, v192
    v_lshlrev_b32 v12, 16, v193
    v_and_b32 v13, 0xffff0000, v193
    v_pk_mul_f32 v[12:13], v[12:13], v[10:11]
    v_cvt_pk_bf16_f32 v193, v12, v13
    v_lshlrev_b32 v33, 16, v193
    v_and_b32 v49, 0xffff0000, v193
    v_lshlrev_b32 v12, 16, v194
    v_and_b32 v13, 0xffff0000, v194
    v_pk_mul_f32 v[12:13], v[12:13], v[10:11]
    v_cvt_pk_bf16_f32 v194, v12, v13
    v_lshlrev_b32 v34, 16, v194
    v_and_b32 v50, 0xffff0000, v194
    v_lshlrev_b32 v12, 16, v195
    v_and_b32 v13, 0xffff0000, v195
    v_pk_mul_f32 v[12:13], v[12:13], v[10:11]
    v_cvt_pk_bf16_f32 v195, v12, v13
    v_lshlrev_b32 v35, 16, v195
    v_and_b32 v51, 0xffff0000, v195
    v_lshlrev_b32 v12, 16, v196
    v_and_b32 v13, 0xffff0000, v196
    v_pk_mul_f32 v[12:13], v[12:13], v[10:11]
    v_cvt_pk_bf16_f32 v196, v12, v13
    v_lshlrev_b32 v36, 16, v196
    v_and_b32 v52, 0xffff0000, v196
    v_lshlrev_b32 v12, 16, v197
    v_and_b32 v13, 0xffff0000, v197
    v_pk_mul_f32 v[12:13], v[12:13], v[10:11]
    v_cvt_pk_bf16_f32 v197, v12, v13
    v_lshlrev_b32 v37, 16, v197
    v_and_b32 v53, 0xffff0000, v197
    v_lshlrev_b32 v12, 16, v198
    v_and_b32 v13, 0xffff0000, v198
    v_pk_mul_f32 v[12:13], v[12:13], v[10:11]
    v_cvt_pk_bf16_f32 v198, v12, v13
    v_lshlrev_b32 v38, 16, v198
    v_and_b32 v54, 0xffff0000, v198
    v_lshlrev_b32 v12, 16, v199
    v_and_b32 v13, 0xffff0000, v199
    v_pk_mul_f32 v[12:13], v[12:13], v[10:11]
    v_cvt_pk_bf16_f32 v199, v12, v13
    v_lshlrev_b32 v39, 16, v199
    v_and_b32 v55, 0xffff0000, v199
    v_lshlrev_b32 v12, 16, v200
    v_and_b32 v13, 0xffff0000, v200
    v_pk_mul_f32 v[12:13], v[12:13], v[10:11]
    v_cvt_pk_bf16_f32 v200, v12, v13
    v_lshlrev_b32 v40, 16, v200
    v_and_b32 v56, 0xffff0000, v200
    v_lshlrev_b32 v12, 16, v201
    v_and_b32 v13, 0xffff0000, v201
    v_pk_mul_f32 v[12:13], v[12:13], v[10:11]
    v_cvt_pk_bf16_f32 v201, v12, v13
    v_lshlrev_b32 v41, 16, v201
    v_and_b32 v57, 0xffff0000, v201
    v_lshlrev_b32 v12, 16, v202
    v_and_b32 v13, 0xffff0000, v202
    v_pk_mul_f32 v[12:13], v[12:13], v[10:11]
    v_cvt_pk_bf16_f32 v202, v12, v13
    v_lshlrev_b32 v42, 16, v202
    v_and_b32 v58, 0xffff0000, v202
    v_lshlrev_b32 v12, 16, v203
    v_and_b32 v13, 0xffff0000, v203
    v_pk_mul_f32 v[12:13], v[12:13], v[10:11]
    v_cvt_pk_bf16_f32 v203, v12, v13
    v_lshlrev_b32 v43, 16, v203
    v_and_b32 v59, 0xffff0000, v203
    v_lshlrev_b32 v12, 16, v204
    v_and_b32 v13, 0xffff0000, v204
    v_pk_mul_f32 v[12:13], v[12:13], v[10:11]
    v_cvt_pk_bf16_f32 v204, v12, v13
    v_lshlrev_b32 v44, 16, v204
    v_and_b32 v60, 0xffff0000, v204
    v_lshlrev_b32 v12, 16, v205
    v_and_b32 v13, 0xffff0000, v205
    v_pk_mul_f32 v[12:13], v[12:13], v[10:11]
    v_cvt_pk_bf16_f32 v205, v12, v13
    v_lshlrev_b32 v45, 16, v205
    v_and_b32 v61, 0xffff0000, v205
    v_lshlrev_b32 v12, 16, v206
    v_and_b32 v13, 0xffff0000, v206
    v_pk_mul_f32 v[12:13], v[12:13], v[10:11]
    v_cvt_pk_bf16_f32 v206, v12, v13
    v_lshlrev_b32 v46, 16, v206
    v_and_b32 v62, 0xffff0000, v206
    v_lshlrev_b32 v12, 16, v207
    v_and_b32 v13, 0xffff0000, v207
    v_pk_mul_f32 v[12:13], v[12:13], v[10:11]
    v_cvt_pk_bf16_f32 v207, v12, v13
    v_lshlrev_b32 v47, 16, v207
    v_and_b32 v63, 0xffff0000, v207
L_nosetup_27:
    s_waitcnt vmcnt(0) lgkmcnt(0)
    s_mov_b64 exec, 1
    buffer_store_dword v253, v252, s[80:83], s30 offen sc1
    s_mov_b64 exec, -1
    s_barrier
    s_cmp_eq_u32 s11, 0
    s_cbranch_scc1 L_w_28
    s_add_u32 m0, s68, 86016
    s_add_u32 s66, s76, s22
    buffer_load_dwordx4 v246, s[72:75], s66 offen lds
    s_add_u32 m0, s68, 87040
    s_add_u32 s66, s77, s22
    buffer_load_dwordx4 v247, s[72:75], s66 offen lds
    s_add_u32 m0, s68, 88064
    s_add_u32 s66, s78, s22
    buffer_load_dwordx4 v246, s[72:75], s66 offen lds
    s_add_u32 m0, s68, 89088
    s_add_u32 s66, s79, s22
    buffer_load_dwordx4 v247, s[72:75], s66 offen lds
    s_add_u32 m0, s68, 102400
    s_add_u32 s66, s76, s28
    buffer_load_dwordx4 v246, s[72:75], s66 offen lds
    s_add_u32 m0, s68, 103424
    s_add_u32 s66, s77, s28
    buffer_load_dwordx4 v247, s[72:75], s66 offen lds
    s_add_u32 m0, s68, 104448
    s_add_u32 s66, s78, s28
    buffer_load_dwordx4 v246, s[72:75], s66 offen lds
    s_add_u32 m0, s68, 105472
    s_add_u32 s66, s79, s28
    buffer_load_dwordx4 v247, s[72:75], s66 offen lds
    s_add_u32 m0, s68, 118784
    s_add_u32 s66, s76, s24
    buffer_load_dwordx4 v246, s[72:75], s66 offen lds
    s_add_u32 m0, s68, 119808
    s_add_u32 s66, s77, s24
    buffer_load_dwordx4 v247, s[72:75], s66 offen lds
    s_add_u32 m0, s68, 120832
    s_add_u32 s66, s78, s24
    buffer_load_dwordx4 v246, s[72:75], s66 offen lds
    s_add_u32 m0, s68, 121856
    s_add_u32 s66, s79, s24
    buffer_load_dwordx4 v247, s[72:75], s66 offen lds
    s_add_u32 m0, s68, -12288
    s_add_u32 s66, s76, s16
    buffer_load_dwordx4 v246, s[72:75], s66 offen lds
    s_add_u32 m0, s68, -11264
    s_add_u32 s66, s77, s16
    buffer_load_dwordx4 v247, s[72:75], s66 offen lds
    s_add_u32 m0, s68, -10240
    s_add_u32 s66, s78, s16
    buffer_load_dwordx4 v246, s[72:75], s66 offen lds
    s_add_u32 m0, s68, -9216
    s_add_u32 s66, s79, s16
    buffer_load_dwordx4 v247, s[72:75], s66 offen lds
    s_add_u32 m0, s68, 4096
    s_add_u32 s66, s76, s25
    buffer_load_dwordx4 v246, s[72:75], s66 offen lds
    s_add_u32 m0, s68, 5120
    s_add_u32 s66, s77, s25
    buffer_load_dwordx4 v247, s[72:75], s66 offen lds
    s_add_u32 m0, s68, 6144
    s_add_u32 s66, s78, s25
    buffer_load_dwordx4 v246, s[72:75], s66 offen lds
    s_add_u32 m0, s68, 7168
    s_add_u32 s66, s79, s25
    buffer_load_dwordx4 v247, s[72:75], s66 offen lds
    s_waitcnt vmcnt(0)
    s_barrier
    s_endpgm
L_w_28:
    ds_read_b128 v[216:219], v16 offset:4096
    ds_read_b128 v[220:223], v16 offset:8192
    ds_read_b128 v[224:227], v17 offset:4096
    ds_read_b128 v[228:231], v17 offset:8192
    ds_read_b128 v[232:235], v18 offset:4096
    ds_read_b128 v[236:239], v18 offset:8192
    s_waitcnt lgkmcnt(4)
    v_mfma_f32_32x32x16_bf16 v[32:47], v[128:131], v[216:219], v[32:47]
    v_mfma_f32_32x32x16_bf16 v[48:63], v[128:131], v[220:223], v[48:63]
    ds_read_b128 v[216:219], v19 offset:4096
    ds_read_b128 v[220:223], v19 offset:8192
    s_waitcnt lgkmcnt(4)
    v_mfma_f32_32x32x16_bf16 v[32:47], v[132:135], v[224:227], v[32:47]
    v_mfma_f32_32x32x16_bf16 v[48:63], v[132:135], v[228:231], v[48:63]
    ds_read_b128 v[224:227], v20 offset:4096
    ds_read_b128 v[228:231], v20 offset:8192
    s_waitcnt lgkmcnt(4)
    v_mfma_f32_32x32x16_bf16 v[32:47], v[136:139], v[232:235], v[32:47]
    v_mfma_f32_32x32x16_bf16 v[48:63], v[136:139], v[236:239], v[48:63]
    ds_read_b128 v[232:235], v21 offset:4096
    ds_read_b128 v[236:239], v21 offset:8192
    s_waitcnt lgkmcnt(4)
    v_mfma_f32_32x32x16_bf16 v[32:47], v[140:143], v[216:219], v[32:47]
    v_mfma_f32_32x32x16_bf16 v[48:63], v[140:143], v[220:223], v[48:63]
    ds_read_b128 v[216:219], v22 offset:4096
    ds_read_b128 v[220:223], v22 offset:8192
    s_waitcnt lgkmcnt(4)
    v_mfma_f32_32x32x16_bf16 v[32:47], v[144:147], v[224:227], v[32:47]
    v_mfma_f32_32x32x16_bf16 v[48:63], v[144:147], v[228:231], v[48:63]
    buffer_load_dword v3, v2, s[80:83], s30 offen sc1
    ds_read_b128 v[224:227], v23 offset:4096
    ds_read_b128 v[228:231], v23 offset:8192
    s_waitcnt lgkmcnt(4)
    v_mfma_f32_32x32x16_bf16 v[32:47], v[148:151], v[232:235], v[32:47]
    v_mfma_f32_32x32x16_bf16 v[48:63], v[148:151], v[236:239], v[48:63]
    ds_read_b128 v[232:235], v16 offset:20480
    ds_read_b128 v[236:239], v16 offset:24576
    s_waitcnt lgkmcnt(4)
    v_mfma_f32_32x32x16_bf16 v[32:47], v[152:155], v[216:219], v[32:47]
    v_mfma_f32_32x32x16_bf16 v[48:63], v[152:155], v[220:223], v[48:63]
    ds_read_b128 v[216:219], v17 offset:20480
    ds_read_b128 v[220:223], v17 offset:24576
    s_waitcnt lgkmcnt(4)
    v_mfma_f32_32x32x16_bf16 v[32:47], v[156:159], v[224:227], v[32:47]
    v_mfma_f32_32x32x16_bf16 v[48:63], v[156:159], v[228:231], v[48:63]
L_flpoll_29:
    buffer_load_dword v5, v2, s[80:83], s30 offen sc1
    s_waitcnt vmcnt(1)
    v_cmp_eq_u32 s[70:71], s12, v3
    s_nop 0
    s_andn2_b32 s15, 262143, s70
    s_cbranch_scc0 L_flok_30
    s_sleep 2
    buffer_load_dword v3, v2, s[80:83], s30 offen sc1
    s_waitcnt vmcnt(1)
    v_cmp_eq_u32 s[70:71], s12, v5
    s_nop 0
    s_andn2_b32 s15, 262143, s70
    s_cbranch_scc0 L_flok_30
    s_sleep 2
    s_sub_u32 s13, s13, 1
    s_cbranch_scc0 L_flpoll_29
L_flok_30:
    buffer_load_dwordx4 v[160:163], v4, s[80:83], s19 offen offset:0 sc1
    buffer_load_dwordx4 v[164:167], v4, s[80:83], s19 offen offset:1024 sc1
    buffer_load_dwordx4 v[168:171], v4, s[80:83], s19 offen offset:2048 sc1
    buffer_load_dwordx4 v[172:175], v4, s[80:83], s19 offen offset:3072 sc1
    s_add_u32 s59, s19, 4096
    buffer_load_dwordx4 v[176:179], v4, s[80:83], s59 offen offset:0 sc1
    buffer_load_dwordx4 v[180:183], v4, s[80:83], s59 offen offset:1024 sc1
    buffer_load_dwordx4 v[184:187], v4, s[80:83], s59 offen offset:2048 sc1
    buffer_load_dwordx4 v[188:191], v4, s[80:83], s59 offen offset:3072 sc1
    buffer_load_dwordx4 v[192:195], v4, s[80:83], s20 offen offset:0 sc1
    buffer_load_dwordx4 v[196:199], v4, s[80:83], s20 offen offset:1024 sc1
    buffer_load_dwordx4 v[200:203], v4, s[80:83], s20 offen offset:2048 sc1
    buffer_load_dwordx4 v[204:207], v4, s[80:83], s20 offen offset:3072 sc1
    ds_read_b128 v[224:227], v18 offset:20480
    ds_read_b128 v[228:231], v18 offset:24576
    s_waitcnt vmcnt(11) lgkmcnt(4)
    v_mfma_f32_32x32x16_bf16 v[32:47], v[160:163], v[232:235], v[32:47]
    v_mfma_f32_32x32x16_bf16 v[48:63], v[160:163], v[236:239], v[48:63]
    s_add_u32 s59, s20, 4096
    buffer_load_dwordx4 v[64:67], v4, s[80:83], s59 offen offset:0 sc1
    ds_read_b128 v[232:235], v19 offset:20480
    ds_read_b128 v[236:239], v19 offset:24576
    s_waitcnt vmcnt(11) lgkmcnt(4)
    v_mfma_f32_32x32x16_bf16 v[32:47], v[164:167], v[216:219], v[32:47]
    v_mfma_f32_32x32x16_bf16 v[48:63], v[164:167], v[220:223], v[48:63]
    buffer_load_dwordx4 v[68:71], v4, s[80:83], s59 offen offset:1024 sc1
    ds_read_b128 v[216:219], v20 offset:20480
    ds_read_b128 v[220:223], v20 offset:24576
    s_waitcnt vmcnt(11) lgkmcnt(4)
    v_mfma_f32_32x32x16_bf16 v[32:47], v[168:171], v[224:227], v[32:47]
    v_mfma_f32_32x32x16_bf16 v[48:63], v[168:171], v[228:231], v[48:63]
    buffer_load_dwordx4 v[72:75], v4, s[80:83], s59 offen offset:2048 sc1
    ds_read_b128 v[224:227], v21 offset:20480
    ds_read_b128 v[228:231], v21 offset:24576
    s_waitcnt vmcnt(11) lgkmcnt(4)
    v_mfma_f32_32x32x16_bf16 v[32:47], v[172:175], v[232:235], v[32:47]
    v_mfma_f32_32x32x16_bf16 v[48:63], v[172:175], v[236:239], v[48:63]
    buffer_load_dwordx4 v[76:79], v4, s[80:83], s59 offen offset:3072 sc1
    ds_read_b128 v[232:235], v22 offset:20480
    ds_read_b128 v[236:239], v22 offset:24576
    s_waitcnt vmcnt(11) lgkmcnt(4)
    v_mfma_f32_32x32x16_bf16 v[32:47], v[176:179], v[216:219], v[32:47]
    v_mfma_f32_32x32x16_bf16 v[48:63], v[176:179], v[220:223], v[48:63]
    buffer_load_dwordx4 v[80:83], v4, s[80:83], s21 offen offset:0 sc1
    ds_read_b128 v[216:219], v23 offset:20480
    ds_read_b128 v[220:223], v23 offset:24576
    s_waitcnt vmcnt(11) lgkmcnt(4)
    v_mfma_f32_32x32x16_bf16 v[32:47], v[180:183], v[224:227], v[32:47]
    v_mfma_f32_32x32x16_bf16 v[48:63], v[180:183], v[228:231], v[48:63]
    buffer_load_dwordx4 v[84:87], v4, s[80:83], s21 offen offset:1024 sc1
    ds_read_b128 v[224:227], v16 offset:36864
    ds_read_b128 v[228:231], v16 offset:40960
    s_waitcnt vmcnt(11) lgkmcnt(4)
    v_mfma_f32_32x32x16_bf16 v[32:47], v[184:187], v[232:235], v[32:47]
    v_mfma_f32_32x32x16_bf16 v[48:63], v[184:187], v[236:239], v[48:63]
    buffer_load_dwordx4 v[88:91], v4, s[80:83], s21 offen offset:2048 sc1
    ds_read_b128 v[232:235], v17 offset:36864
    ds_read_b128 v[236:239], v17 offset:40960
    s_waitcnt vmcnt(11) lgkmcnt(4)
    v_mfma_f32_32x32x16_bf16 v[32:47], v[188:191], v[216:219], v[32:47]
    v_mfma_f32_32x32x16_bf16 v[48:63], v[188:191], v[220:223], v[48:63]
    buffer_load_dwordx4 v[92:95], v4, s[80:83], s21 offen offset:3072 sc1
    ds_read_b128 v[216:219], v18 offset:36864
    ds_read_b128 v[220:223], v18 offset:40960
    s_waitcnt vmcnt(11) lgkmcnt(4)
    v_mfma_f32_32x32x16_bf16 v[32:47], v[192:195], v[224:227], v[32:47]
    v_mfma_f32_32x32x16_bf16 v[48:63], v[192:195], v[228:231], v[48:63]
    s_add_u32 s59, s21, 4096
    buffer_load_dwordx4 v[96:99], v4, s[80:83], s59 offen offset:0 sc1
    ds_read_b128 v[224:227], v19 offset:36864
    ds_read_b128 v[228:231], v19 offset:40960
    s_waitcnt vmcnt(11) lgkmcnt(4)
    v_mfma_f32_32x32x16_bf16 v[32:47], v[196:199], v[232:235], v[32:47]
    v_mfma_f32_32x32x16_bf16 v[48:63], v[196:199], v[236:239], v[48:63]
    buffer_load_dwordx4 v[100:103], v4, s[80:83], s59 offen offset:1024 sc1
    ds_read_b128 v[232:235], v20 offset:36864
    ds_read_b128 v[236:239], v20 offset:40960
    s_waitcnt vmcnt(11) lgkmcnt(4)
    v_mfma_f32_32x32x16_bf16 v[32:47], v[200:203], v[216:219], v[32:47]
    v_mfma_f32_32x32x16_bf16 v[48:63], v[200:203], v[220:223], v[48:63]
    buffer_load_dwordx4 v[104:107], v4, s[80:83], s59 offen offset:2048 sc1
    ds_read_b128 v[216:219], v21 offset:36864
    ds_read_b128 v[220:223], v21 offset:40960
    s_waitcnt vmcnt(11) lgkmcnt(4)
    v_mfma_f32_32x32x16_bf16 v[32:47], v[204:207], v[224:227], v[32:47]
    v_mfma_f32_32x32x16_bf16 v[48:63], v[204:207], v[228:231], v[48:63]
    buffer_load_dwordx4 v[108:111], v4, s[80:83], s59 offen offset:3072 sc1
    ds_read_b128 v[224:227], v22 offset:36864
    ds_read_b128 v[228:231], v22 offset:40960
    s_waitcnt vmcnt(11) lgkmcnt(4)
    v_mfma_f32_32x32x16_bf16 v[32:47], v[64:67], v[232:235], v[32:47]
    v_mfma_f32_32x32x16_bf16 v[48:63], v[64:67], v[236:239], v[48:63]
    buffer_load_dwordx4 v[112:115], v4, s[80:83], s22 offen offset:0 sc1
    ds_read_b128 v[232:235], v23 offset:36864
    ds_read_b128 v[236:239], v23 offset:40960
    s_waitcnt vmcnt(11) lgkmcnt(4)
    v_mfma_f32_32x32x16_bf16 v[32:47], v[68:71], v[216:219], v[32:47]
    v_mfma_f32_32x32x16_bf16 v[48:63], v[68:71], v[220:223], v[48:63]
    buffer_load_dwordx4 v[116:119], v4, s[80:83], s22 offen offset:1024 sc1
    ds_read_b128 v[216:219], v16 offset:53248
    ds_read_b128 v[220:223], v16 offset:57344
    s_waitcnt vmcnt(11) lgkmcnt(4)
    v_mfma_f32_32x32x16_bf16 v[32:47], v[72:75], v[224:227], v[32:47]
    v_mfma_f32_32x32x16_bf16 v[48:63], v[72:75], v[228:231], v[48:63]
    buffer_load_dwordx4 v[120:123], v4, s[80:83], s22 offen offset:2048 sc1
    ds_read_b128 v[224:227], v17 offset:53248
    ds_read_b128 v[228:231], v17 offset:57344
    s_waitcnt vmcnt(11) lgkmcnt(4)
    v_mfma_f32_32x32x16_bf16 v[32:47], v[76:79], v[232:235], v[32:47]
    v_mfma_f32_32x32x16_bf16 v[48:63], v[76:79], v[236:239], v[48:63]
    buffer_load_dwordx4 v[124:127], v4, s[80:83], s22 offen offset:3072 sc1
    ds_read_b128 v[232:235], v18 offset:53248
    ds_read_b128 v[236:239], v18 offset:57344
    s_waitcnt vmcnt(11) lgkmcnt(4)
    v_mfma_f32_32x32x16_bf16 v[32:47], v[80:83], v[216:219], v[32:47]
    v_mfma_f32_32x32x16_bf16 v[48:63], v[80:83], v[220:223], v[48:63]
    s_add_u32 s59, s22, 4096
    buffer_load_dwordx4 v[160:163], v4, s[80:83], s59 offen offset:0 sc1
    ds_read_b128 v[216:219], v19 offset:53248
    ds_read_b128 v[220:223], v19 offset:57344
    s_waitcnt vmcnt(11) lgkmcnt(4)
    v_mfma_f32_32x32x16_bf16 v[32:47], v[84:87], v[224:227], v[32:47]
    v_mfma_f32_32x32x16_bf16 v[48:63], v[84:87], v[228:231], v[48:63]
    buffer_load_dwordx4 v[164:167], v4, s[80:83], s59 offen offset:1024 sc1
    ds_read_b128 v[224:227], v20 offset:53248
    ds_read_b128 v[228:231], v20 offset:57344
    s_waitcnt vmcnt(11) lgkmcnt(4)
    v_mfma_f32_32x32x16_bf16 v[32:47], v[88:91], v[232:235], v[32:47]
    v_mfma_f32_32x32x16_bf16 v[48:63], v[88:91], v[236:239], v[48:63]
    buffer_load_dwordx4 v[168:171], v4, s[80:83], s59 offen offset:2048 sc1
    ds_read_b128 v[232:235], v21 offset:53248
    ds_read_b128 v[236:239], v21 offset:57344
    s_waitcnt vmcnt(11) lgkmcnt(4)
    v_mfma_f32_32x32x16_bf16 v[32:47], v[92:95], v[216:219], v[32:47]
    v_mfma_f32_32x32x16_bf16 v[48:63], v[92:95], v[220:223], v[48:63]
    buffer_load_dwordx4 v[172:175], v4, s[80:83], s59 offen offset:3072 sc1
    ds_read_b128 v[216:219], v22 offset:53248
    ds_read_b128 v[220:223], v22 offset:57344
    s_waitcnt vmcnt(11) lgkmcnt(4)
    v_mfma_f32_32x32x16_bf16 v[32:47], v[96:99], v[224:227], v[32:47]
    v_mfma_f32_32x32x16_bf16 v[48:63], v[96:99], v[228:231], v[48:63]
    buffer_load_dwordx4 v[176:179], v4, s[80:83], s23 offen offset:0 sc1
    ds_read_b128 v[224:227], v23 offset:53248
    ds_read_b128 v[228:231], v23 offset:57344
    s_waitcnt vmcnt(11) lgkmcnt(4)
    v_mfma_f32_32x32x16_bf16 v[32:47], v[100:103], v[232:235], v[32:47]
    v_mfma_f32_32x32x16_bf16 v[48:63], v[100:103], v[236:239], v[48:63]
    buffer_load_dwordx4 v[180:183], v4, s[80:83], s23 offen offset:1024 sc1
    s_barrier
    v_add_u32 v16, 0x10000, v16
    v_add_u32 v17, 0x10000, v17
    v_add_u32 v18, 0x10000, v18
    v_add_u32 v19, 0x10000, v19
    v_add_u32 v20, 0x10000, v20
    v_add_u32 v21, 0x10000, v21
    v_add_u32 v22, 0x10000, v22
    v_add_u32 v23, 0x10000, v23
    ds_read_b128 v[232:235], v16 offset:4096
    ds_read_b128 v[236:239], v16 offset:8192
    s_waitcnt vmcnt(11) lgkmcnt(4)
    v_mfma_f32_32x32x16_bf16 v[32:47], v[104:107], v[216:219], v[32:47]
    v_mfma_f32_32x32x16_bf16 v[48:63], v[104:107], v[220:223], v[48:63]
    buffer_load_dwordx4 v[184:187], v4, s[80:83], s23 offen offset:2048 sc1
    ds_read_b128 v[216:219], v17 offset:4096
    ds_read_b128 v[220:223], v17 offset:8192
    s_waitcnt vmcnt(11) lgkmcnt(4)
    v_mfma_f32_32x32x16_bf16 v[32:47], v[108:111], v[224:227], v[32:47]
    v_mfma_f32_32x32x16_bf16 v[48:63], v[108:111], v[228:231], v[48:63]
    buffer_load_dwordx4 v[188:191], v4, s[80:83], s23 offen offset:3072 sc1
    ds_read_b128 v[224:227], v18 offset:4096
    ds_read_b128 v[228:231], v18 offset:8192
    s_waitcnt vmcnt(11) lgkmcnt(4)
    v_mfma_f32_32x32x16_bf16 v[32:47], v[112:115], v[232:235], v[32:47]
    v_mfma_f32_32x32x16_bf16 v[48:63], v[112:115], v[236:239], v[48:63]
    s_add_u32 s59, s23, 4096
    buffer_load_dwordx4 v[192:195], v4, s[80:83], s59 offen offset:0 sc1
    ds_read_b128 v[232:235], v19 offset:4096
    ds_read_b128 v[236:239], v19 offset:8192
    s_waitcnt vmcnt(11) lgkmcnt(4)
    v_mfma_f32_32x32x16_bf16 v[32:47], v[116:119], v[216:219], v[32:47]
    v_mfma_f32_32x32x16_bf16 v[48:63], v[116:119], v[220:223], v[48:63]
    buffer_load_dwordx4 v[196:199], v4, s[80:83], s59 offen offset:1024 sc1
    ds_read_b128 v[216:219], v20 offset:4096
    ds_read_b128 v[220:223], v20 offset:8192
    s_waitcnt vmcnt(11) lgkmcnt(4)
    v_mfma_f32_32x32x16_bf16 v[32:47], v[120:123], v[224:227], v[32:47]
    v_mfma_f32_32x32x16_bf16 v[48:63], v[120:123], v[228:231], v[48:63]
    buffer_load_dwordx4 v[200:203], v4, s[80:83], s59 offen offset:2048 sc1
    ds_read_b128 v[224:227], v21 offset:4096
    ds_read_b128 v[228:231], v21 offset:8192
    s_waitcnt vmcnt(11) lgkmcnt(4)
    v_mfma_f32_32x32x16_bf16 v[32:47], v[124:127], v[232:235], v[32:47]
    v_mfma_f32_32x32x16_bf16 v[48:63], v[124:127], v[236:239], v[48:63]
    buffer_load_dwordx4 v[204:207], v4, s[80:83], s59 offen offset:3072 sc1
    ds_read_b128 v[232:235], v22 offset:4096
    ds_read_b128 v[236:239], v22 offset:8192
    s_waitcnt vmcnt(11) lgkmcnt(4)
    v_mfma_f32_32x32x16_bf16 v[32:47], v[160:163], v[216:219], v[32:47]
    v_mfma_f32_32x32x16_bf16 v[48:63], v[160:163], v[220:223], v[48:63]
    buffer_load_dwordx4 v[64:67], v4, s[80:83], s24 offen offset:0 sc1
    ds_read_b128 v[216:219], v23 offset:4096
    ds_read_b128 v[220:223], v23 offset:8192
    s_waitcnt vmcnt(11) lgkmcnt(4)
    v_mfma_f32_32x32x16_bf16 v[32:47], v[164:167], v[224:227], v[32:47]
    v_mfma_f32_32x32x16_bf16 v[48:63], v[164:167], v[228:231], v[48:63]
    buffer_load_dwordx4 v[68:71], v4, s[80:83], s24 offen offset:1024 sc1
    ds_read_b128 v[224:227], v16 offset:20480
    ds_read_b128 v[228:231], v16 offset:24576
    s_waitcnt vmcnt(11) lgkmcnt(4)
    v_mfma_f32_32x32x16_bf16 v[32:47], v[168:171], v[232:235], v[32:47]
    v_mfma_f32_32x32x16_bf16 v[48:63], v[168:171], v[236:239], v[48:63]
    buffer_load_dwordx4 v[72:75], v4, s[80:83], s24 offen offset:2048 sc1
    ds_read_b128 v[232:235], v17 offset:20480
    ds_read_b128 v[236:239], v17 offset:24576
    s_waitcnt vmcnt(11) lgkmcnt(4)
    v_mfma_f32_32x32x16_bf16 v[32:47], v[172:175], v[216:219], v[32:47]
    v_mfma_f32_32x32x16_bf16 v[48:63], v[172:175], v[220:223], v[48:63]
    buffer_load_dwordx4 v[76:79], v4, s[80:83], s24 offen offset:3072 sc1
    ds_read_b128 v[216:219], v18 offset:20480
    ds_read_b128 v[220:223], v18 offset:24576
    s_waitcnt vmcnt(11) lgkmcnt(4)
    v_mfma_f32_32x32x16_bf16 v[32:47], v[176:179], v[224:227], v[32:47]
    v_mfma_f32_32x32x16_bf16 v[48:63], v[176:179], v[228:231], v[48:63]
    s_add_u32 s59, s24, 4096
    buffer_load_dwordx4 v[80:83], v4, s[80:83], s59 offen offset:0 sc1
    ds_read_b128 v[224:227], v19 offset:20480
    ds_read_b128 v[228:231], v19 offset:24576
    s_waitcnt vmcnt(11) lgkmcnt(4)
    v_mfma_f32_32x32x16_bf16 v[32:47], v[180:183], v[232:235], v[32:47]
    v_mfma_f32_32x32x16_bf16 v[48:63], v[180:183], v[236:239], v[48:63]
    buffer_load_dwordx4 v[84:87], v4, s[80:83], s59 offen offset:1024 sc1
    ds_read_b128 v[232:235], v20 offset:20480
    ds_read_b128 v[236:239], v20 offset:24576
    s_waitcnt vmcnt(11) lgkmcnt(4)
    v_mfma_f32_32x32x16_bf16 v[32:47], v[184:187], v[216:219], v[32:47]
    v_mfma_f32_32x32x16_bf16 v[48:63], v[184:187], v[220:223], v[48:63]
    buffer_load_dwordx4 v[88:91], v4, s[80:83], s59 offen offset:2048 sc1
    ds_read_b128 v[216:219], v21 offset:20480
    ds_read_b128 v[220:223], v21 offset:24576
    s_waitcnt vmcnt(11) lgkmcnt(4)
    v_mfma_f32_32x32x16_bf16 v[32:47], v[188:191], v[224:227], v[32:47]
    v_mfma_f32_32x32x16_bf16 v[48:63], v[188:191], v[228:231], v[48:63]
    buffer_load_dwordx4 v[92:95], v4, s[80:83], s59 offen offset:3072 sc1
    ds_read_b128 v[224:227], v22 offset:20480
    ds_read_b128 v[228:231], v22 offset:24576
    s_waitcnt vmcnt(11) lgkmcnt(4)
    v_mfma_f32_32x32x16_bf16 v[32:47], v[192:195], v[232:235], v[32:47]
    v_mfma_f32_32x32x16_bf16 v[48:63], v[192:195], v[236:239], v[48:63]
    buffer_load_dwordx4 v[96:99], v4, s[80:83], s16 offen offset:0 sc1
    ds_read_b128 v[232:235], v23 offset:20480
    ds_read_b128 v[236:239], v23 offset:24576
    s_waitcnt vmcnt(11) lgkmcnt(4)
    v_mfma_f32_32x32x16_bf16 v[32:47], v[196:199], v[216:219], v[32:47]
    v_mfma_f32_32x32x16_bf16 v[48:63], v[196:199], v[220:223], v[48:63]
    buffer_load_dwordx4 v[100:103], v4, s[80:83], s16 offen offset:1024 sc1
    ds_read_b128 v[216:219], v16 offset:36864
    ds_read_b128 v[220:223], v16 offset:40960
    s_waitcnt vmcnt(11) lgkmcnt(4)
    v_mfma_f32_32x32x16_bf16 v[32:47], v[200:203], v[224:227], v[32:47]
    v_mfma_f32_32x32x16_bf16 v[48:63], v[200:203], v[228:231], v[48:63]
    buffer_load_dwordx4 v[104:107], v4, s[80:83], s16 offen offset:2048 sc1
    ds_read_b128 v[224:227], v17 offset:36864
    ds_read_b128 v[228:231], v17 offset:40960
    s_waitcnt vmcnt(11) lgkmcnt(4)
    v_mfma_f32_32x32x16_bf16 v[32:47], v[204:207], v[232:235], v[32:47]
    v_mfma_f32_32x32x16_bf16 v[48:63], v[204:207], v[236:239], v[48:63]
    buffer_load_dwordx4 v[108:111], v4, s[80:83], s16 offen offset:3072 sc1
    ds_read_b128 v[232:235], v18 offset:36864
    ds_read_b128 v[236:239], v18 offset:40960
    s_waitcnt vmcnt(11) lgkmcnt(4)
    v_mfma_f32_32x32x16_bf16 v[32:47], v[64:67], v[216:219], v[32:47]
    v_mfma_f32_32x32x16_bf16 v[48:63], v[64:67], v[220:223], v[48:63]
    s_add_u32 s59, s16, 4096
    buffer_load_dwordx4 v[112:115], v4, s[80:83], s59 offen offset:0 sc1
    ds_read_b128 v[216:219], v19 offset:36864
    ds_read_b128 v[220:223], v19 offset:40960
    s_waitcnt vmcnt(11) lgkmcnt(4)
    v_mfma_f32_32x32x16_bf16 v[32:47], v[68:71], v[224:227], v[32:47]
    v_mfma_f32_32x32x16_bf16 v[48:63], v[68:71], v[228:231], v[48:63]
    buffer_load_dwordx4 v[116:119], v4, s[80:83], s59 offen offset:1024 sc1
    ds_read_b128 v[224:227], v20 offset:36864
    ds_read_b128 v[228:231], v20 offset:40960
    s_waitcnt vmcnt(11) lgkmcnt(4)
    v_mfma_f32_32x32x16_bf16 v[32:47], v[72:75], v[232:235], v[32:47]
    v_mfma_f32_32x32x16_bf16 v[48:63], v[72:75], v[236:239], v[48:63]
    buffer_load_dwordx4 v[120:123], v4, s[80:83], s59 offen offset:2048 sc1
    ds_read_b128 v[232:235], v21 offset:36864
    ds_read_b128 v[236:239], v21 offset:40960
    s_waitcnt vmcnt(11) lgkmcnt(4)
    v_mfma_f32_32x32x16_bf16 v[32:47], v[76:79], v[216:219], v[32:47]
    v_mfma_f32_32x32x16_bf16 v[48:63], v[76:79], v[220:223], v[48:63]
    buffer_load_dwordx4 v[124:127], v4, s[80:83], s59 offen offset:3072 sc1
    ds_read_b128 v[216:219], v22 offset:36864
    ds_read_b128 v[220:223], v22 offset:40960
    s_waitcnt vmcnt(11) lgkmcnt(4)
    v_mfma_f32_32x32x16_bf16 v[32:47], v[80:83], v[224:227], v[32:47]
    v_mfma_f32_32x32x16_bf16 v[48:63], v[80:83], v[228:231], v[48:63]
    buffer_load_dwordx4 v[160:163], v4, s[80:83], s17 offen offset:0 sc1
    ds_read_b128 v[224:227], v23 offset:36864
    ds_read_b128 v[228:231], v23 offset:40960
    s_waitcnt vmcnt(11) lgkmcnt(4)
    v_mfma_f32_32x32x16_bf16 v[32:47], v[84:87], v[232:235], v[32:47]
    v_mfma_f32_32x32x16_bf16 v[48:63], v[84:87], v[236:239], v[48:63]
    buffer_load_dwordx4 v[164:167], v4, s[80:83], s17 offen offset:1024 sc1
    v_subrev_u32 v16, 98304, v16
    v_subrev_u32 v17, 98304, v17
    v_subrev_u32 v18, 98304, v18
    v_subrev_u32 v19, 98304, v19
    v_subrev_u32 v20, 98304, v20
    v_subrev_u32 v21, 98304, v21
    v_subrev_u32 v22, 98304, v22
    v_subrev_u32 v23, 98304, v23
    ds_read_b128 v[232:235], v16 offset:4096
    ds_read_b128 v[236:239], v16 offset:8192
    s_waitcnt vmcnt(11) lgkmcnt(4)
    v_mfma_f32_32x32x16_bf16 v[32:47], v[88:91], v[216:219], v[32:47]
    v_mfma_f32_32x32x16_bf16 v[48:63], v[88:91], v[220:223], v[48:63]
    buffer_load_dwordx4 v[168:171], v4, s[80:83], s17 offen offset:2048 sc1
    ds_read_b128 v[216:219], v17 offset:4096
    ds_read_b128 v[220:223], v17 offset:8192
    s_waitcnt vmcnt(11) lgkmcnt(4)
    v_mfma_f32_32x32x16_bf16 v[32:47], v[92:95], v[224:227], v[32:47]
    v_mfma_f32_32x32x16_bf16 v[48:63], v[92:95], v[228:231], v[48:63]
    buffer_load_dwordx4 v[172:175], v4, s[80:83], s17 offen offset:3072 sc1
    ds_read_b128 v[224:227], v18 offset:4096
    ds_read_b128 v[228:231], v18 offset:8192
    s_waitcnt vmcnt(11) lgkmcnt(4)
    v_mfma_f32_32x32x16_bf16 v[32:47], v[96:99], v[232:235], v[32:47]
    v_mfma_f32_32x32x16_bf16 v[48:63], v[96:99], v[236:239], v[48:63]
    s_add_u32 s59, s17, 4096
    buffer_load_dwordx4 v[176:179], v4, s[80:83], s59 offen offset:0 sc1
    ds_read_b128 v[232:235], v19 offset:4096
    ds_read_b128 v[236:239], v19 offset:8192
    s_waitcnt vmcnt(11) lgkmcnt(4)
    v_mfma_f32_32x32x16_bf16 v[32:47], v[100:103], v[216:219], v[32:47]
    v_mfma_f32_32x32x16_bf16 v[48:63], v[100:103], v[220:223], v[48:63]
    buffer_load_dwordx4 v[180:183], v4, s[80:83], s59 offen offset:1024 sc1
    ds_read_b128 v[216:219], v20 offset:4096
    ds_read_b128 v[220:223], v20 offset:8192
    s_waitcnt vmcnt(11) lgkmcnt(4)
    v_mfma_f32_32x32x16_bf16 v[32:47], v[104:107], v[224:227], v[32:47]
    v_mfma_f32_32x32x16_bf16 v[48:63], v[104:107], v[228:231], v[48:63]
    buffer_load_dwordx4 v[184:187], v4, s[80:83], s59 offen offset:2048 sc1
    ds_read_b128 v[224:227], v21 offset:4096
    ds_read_b128 v[228:231], v21 offset:8192
    s_waitcnt vmcnt(11) lgkmcnt(4)
    v_mfma_f32_32x32x16_bf16 v[32:47], v[108:111], v[232:235], v[32:47]
    v_mfma_f32_32x32x16_bf16 v[48:63], v[108:111], v[236:239], v[48:63]
    buffer_load_dwordx4 v[188:191], v4, s[80:83], s59 offen offset:3072 sc1
    ds_read_b128 v[232:235], v22 offset:4096
    ds_read_b128 v[236:239], v22 offset:8192
    s_waitcnt vmcnt(11) lgkmcnt(4)
    v_mfma_f32_32x32x16_bf16 v[32:47], v[112:115], v[216:219], v[32:47]
    v_mfma_f32_32x32x16_bf16 v[48:63], v[112:115], v[220:223], v[48:63]
    ds_read_b128 v[216:219], v23 offset:4096
    ds_read_b128 v[220:223], v23 offset:8192
    s_waitcnt vmcnt(10) lgkmcnt(4)
    v_mfma_f32_32x32x16_bf16 v[32:47], v[116:119], v[224:227], v[32:47]
    v_mfma_f32_32x32x16_bf16 v[48:63], v[116:119], v[228:231], v[48:63]
    ds_read_b128 v[224:227], v16 offset:20480
    ds_read_b128 v[228:231], v16 offset:24576
    s_waitcnt vmcnt(9) lgkmcnt(4)
    v_mfma_f32_32x32x16_bf16 v[32:47], v[120:123], v[232:235], v[32:47]
    v_mfma_f32_32x32x16_bf16 v[48:63], v[120:123], v[236:239], v[48:63]
    ds_read_b128 v[232:235], v17 offset:20480
    ds_read_b128 v[236:239], v17 offset:24576
    s_waitcnt vmcnt(8) lgkmcnt(4)
    v_mfma_f32_32x32x16_bf16 v[32:47], v[124:127], v[216:219], v[32:47]
    v_mfma_f32_32x32x16_bf16 v[48:63], v[124:127], v[220:223], v[48:63]
    ds_read_b128 v[216:219], v18 offset:20480
    ds_read_b128 v[220:223], v18 offset:24576
    s_waitcnt vmcnt(7) lgkmcnt(4)
    v_mfma_f32_32x32x16_bf16 v[32:47], v[160:163], v[224:227], v[32:47]
    v_mfma_f32_32x32x16_bf16 v[48:63], v[160:163], v[228:231], v[48:63]
    ds_read_b128 v[224:227], v19 offset:20480
    ds_read_b128 v[228:231], v19 offset:24576
    s_waitcnt vmcnt(6) lgkmcnt(4)
    v_mfma_f32_32x32x16_bf16 v[32:47], v[164:167], v[232:235], v[32:47]
    v_mfma_f32_32x32x16_bf16 v[48:63], v[164:167], v[236:239], v[48:63]
    ds_read_b128 v[232:235], v20 offset:20480
    ds_read_b128 v[236:239], v20 offset:24576
    s_waitcnt vmcnt(5) lgkmcnt(4)
    v_mfma_f32_32x32x16_bf16 v[32:47], v[168:171], v[216:219], v[32:47]
    v_mfma_f32_32x32x16_bf16 v[48:63], v[168:171], v[220:223], v[48:63]
    ds_read_b128 v[216:219], v21 offset:20480
    ds_read_b128 v[220:223], v21 offset:24576
    s_waitcnt vmcnt(4) lgkmcnt(4)
    v_mfma_f32_32x32x16_bf16 v[32:47], v[172:175], v[224:227], v[32:47]
    v_mfma_f32_32x32x16_bf16 v[48:63], v[172:175], v[228:231], v[48:63]
    ds_read_b128 v[224:227], v22 offset:20480
    ds_read_b128 v[228:231], v22 offset:24576
    s_waitcnt vmcnt(3) lgkmcnt(4)
    v_mfma_f32_32x32x16_bf16 v[32:47], v[176:179], v[232:235], v[32:47]
    v_mfma_f32_32x32x16_bf16 v[48:63], v[176:179], v[236:239], v[48:63]
    ds_read_b128 v[232:235], v23 offset:20480
    ds_read_b128 v[236:239], v23 offset:24576
    s_waitcnt vmcnt(2) lgkmcnt(4)
    v_mfma_f32_32x32x16_bf16 v[32:47], v[180:183], v[216:219], v[32:47]
    v_mfma_f32_32x32x16_bf16 v[48:63], v[180:183], v[220:223], v[48:63]
    s_waitcnt vmcnt(1) lgkmcnt(2)
    v_mfma_f32_32x32x16_bf16 v[32:47], v[184:187], v[224:227], v[32:47]
    v_mfma_f32_32x32x16_bf16 v[48:63], v[184:187], v[228:231], v[48:63]
    s_waitcnt vmcnt(0) lgkmcnt(0)
    v_mfma_f32_32x32x16_bf16 v[32:47], v[188:191], v[232:235], v[32:47]
    v_mfma_f32_32x32x16_bf16 v[48:63], v[188:191], v[236:239], v[48:63]
    s_nop 10
    v_mov_b32 v64, v32
    v_mov_b32 v65, v48
    s_add_u32 s15, s14, 0
    buffer_store_dwordx2 v[64:65], v9, s[44:47], s15 offen
    v_mov_b32 v66, v33
    v_mov_b32 v67, v49
    s_add_u32 s15, s14, 4608
    buffer_store_dwordx2 v[66:67], v9, s[44:47], s15 offen
    v_mov_b32 v68, v34
    v_mov_b32 v69, v50
    s_add_u32 s15, s14, 9216
    buffer_store_dwordx2 v[68:69], v9, s[44:47], s15 offen
    v_mov_b32 v70, v35
    v_mov_b32 v71, v51
    s_add_u32 s15, s14, 13824
    buffer_store_dwordx2 v[70:71], v9, s[44:47], s15 offen
    v_mov_b32 v72, v36
    v_mov_b32 v73, v52
    s_add_u32 s15, s14, 36864
    buffer_store_dwordx2 v[72:73], v9, s[44:47], s15 offen
    v_mov_b32 v74, v37
    v_mov_b32 v75, v53
    s_add_u32 s15, s14, 41472
    buffer_store_dwordx2 v[74:75], v9, s[44:47], s15 offen
    v_mov_b32 v76, v38
    v_mov_b32 v77, v54
    s_add_u32 s15, s14, 46080
    buffer_store_dwordx2 v[76:77], v9, s[44:47], s15 offen
    v_mov_b32 v78, v39
    v_mov_b32 v79, v55
    s_add_u32 s15, s14, 50688
    buffer_store_dwordx2 v[78:79], v9, s[44:47], s15 offen
    v_mov_b32 v80, v40
    v_mov_b32 v81, v56
    s_add_u32 s15, s14, 73728
    buffer_store_dwordx2 v[80:81], v9, s[44:47], s15 offen
    v_mov_b32 v82, v41
    v_mov_b32 v83, v57
    s_add_u32 s15, s14, 78336
    buffer_store_dwordx2 v[82:83], v9, s[44:47], s15 offen
    v_mov_b32 v84, v42
    v_mov_b32 v85, v58
    s_add_u32 s15, s14, 82944
    buffer_store_dwordx2 v[84:85], v9, s[44:47], s15 offen
    v_mov_b32 v86, v43
    v_mov_b32 v87, v59
    s_add_u32 s15, s14, 87552
    buffer_store_dwordx2 v[86:87], v9, s[44:47], s15 offen
    v_mov_b32 v88, v44
    v_mov_b32 v89, v60
    s_add_u32 s15, s14, 110592
    buffer_store_dwordx2 v[88:89], v9, s[44:47], s15 offen
    v_mov_b32 v90, v45
    v_mov_b32 v91, v61
    s_add_u32 s15, s14, 115200
    buffer_store_dwordx2 v[90:91], v9, s[44:47], s15 offen
    v_mov_b32 v92, v46
    v_mov_b32 v93, v62
    s_add_u32 s15, s14, 119808
    buffer_store_dwordx2 v[92:93], v9, s[44:47], s15 offen
    v_mov_b32 v94, v47
    v_mov_b32 v95, v63
    s_add_u32 s15, s14, 124416
    buffer_store_dwordx2 v[94:95], v9, s[44:47], s15 offen
    s_endpgm
L_roleA:
    s_sub_u32 s5, s5, s8
    s_mov_b32 s73, s9
    s_mul_i32 s78, s9, 3
    s_add_u32 s78, s78, 12
    s_cmp_ge_u32 s5, s78
    s_cbranch_scc1 L_exit
    s_mov_b32 s14, s5
    s_lshl_b32 s13, s14, 3
    s_add_u32 s13, s13, s3
    s_lshr_b32 s15, s4, 1
    s_mul_i32 s15, s15, 27
    s_mul_i32 s59, s9, 12
    s_add_u32 s15, s15, s59
    s_mul_i32 s59, s15, 43
    s_lshr_b32 s59, s59, 9
    s_mov_b32 s11, s59
    s_add_u32 s59, s15, s78
    s_sub_u32 s59, s59, 1
    s_mul_i32 s59, s59, 43
    s_lshr_b32 s72, s59, 9
    s_add_u32 s14, s14, s15
    s_mov_b32 s36, s14
    s_mul_i32 s15, s14, 171
    s_lshr_b32 s15, s15, 9
    s_mul_i32 s59, s15, 3
    s_sub_u32 s10, s14, s59
    s_lshl_b32 s8, s15, 4
    s_mul_i32 s14, s10, 6
    s_min_u32 s14, s14, 10
    s_add_u32 s8, s8, s14
    s_lshr_b32 s14, s3, 1
    s_add_u32 s14, s14, 2
    s_cmp_lt_u32 s3, 4
    s_cselect_b32 s9, s3, s14
    s_cselect_b32 s12, 2, 1
    s_add_u32 s14, s8, s9
    s_lshl_b32 s15, s14, 8
    v_lshl_add_u32 v2, v1, 2, s15
    s_lshl_b32 s15, s14, 1
    v_mov_b32 v3, s15
    s_lshl_b32 s15, s8, 1
    v_mov_b32 v35, s15
    s_waitcnt lgkmcnt(0)
    global_load_dword v20, v2, s[18:19]
    global_load_dword v21, v2, s[20:21]
    global_load_dword v22, v2, s[22:23]
    global_load_dword v23, v2, s[24:25]
    global_load_dword v24, v2, s[26:27]
    global_load_dword v25, v2, s[28:29]
    global_load_ushort v26, v3, s[30:31]
    global_load_dwordx3 v[28:30], v35, s[32:33]
    s_mov_b32 s60, s16
    s_mov_b32 s61, s17
    s_mov_b32 s62, 2359296
    s_mov_b32 s63, 0x20000
    s_mov_b32 s64, s52
    s_mov_b32 s65, s53
    s_mov_b32 s66, 9437184
    s_mov_b32 s67, 0x20000
    s_mov_b32 s80, s56
    s_mov_b32 s81, s57
    s_mov_b32 s82, 9437184
    s_mov_b32 s83, 0x20000
    s_lshl_b32 s14, s36, 13
    s_add_u32 s14, s14, 4096
    s_cmp_eq_u32 s36, 18
    s_cselect_b32 s14, 262144, s14
    s_cmp_gt_u32 s36, 18
    s_cselect_b32 s14, 9437184, s14
    s_cmp_lg_u32 s3, 7
    s_cselect_b32 s14, 9437184, s14
    v_lshlrev_b32 v2, 7, v1
    buffer_load_dword v243, v2, s[80:83], s14 offen
    s_mul_i32 s14, s3, s78
    s_add_u32 s14, s14, s5
    s_cmp_eq_u32 s73, 0
    s_cselect_b32 s59, 53, 47
    s_min_u32 s14, s14, s59
    s_cmp_eq_u32 s73, 0
    s_movk_i32 s59, 3641
    s_cselect_b32 s59, s59, 0x1000
    s_cselect_b32 s79, 18, 16
    s_mul_i32 s15, s14, s59
    s_lshr_b32 s15, s15, 16
    s_mul_i32 s59, s15, s79
    s_sub_u32 s14, s14, s59
    s_add_u32 s15, s15, 2
    s_lshl_b32 s15, s15, 7
    s_lshr_b32 s79, s79, 1
    s_add_u32 s79, s79, 4
    s_cmp_lt_u32 s14, s79
    s_cselect_b32 s6, s40, s42
    s_cselect_b32 s7, s41, s43
    s_cselect_b32 s59, 8, s79
    s_sub_u32 s59, s14, s59
    s_mul_i32 s79, s73, 5
    s_add_u32 s59, s59, s79
    s_and_b32 s79, s4, 6
    s_lshl2_add_u32 s79, s79, s14
    s_cmp_lt_u32 s14, 8
    s_cselect_b32 s6, s34, s6
    s_cselect_b32 s7, s35, s7
    s_cselect_b32 s14, s79, s59
    s_mul_i32 s14, s14, 73728
    s_add_u32 s14, s14, s15
    v_mul_u32_u24 v2, 1152, v1
    v_add_u32 v2, s14, v2
    global_load_dword v251, v2, s[6:7]
    s_mul_i32 s14, s3, s78
    s_add_u32 s14, s14, s5
    s_cmp_eq_u32 s73, 0
    s_movk_i32 s59, 71
    s_cselect_b32 s59, s59, 63
    s_min_u32 s14, s14, s59
    s_cmp_eq_u32 s73, 0
    s_movk_i32 s59, 3641
    s_cselect_b32 s59, s59, 0x1000
    s_cselect_b32 s79, 18, 16
    s_mul_i32 s15, s14, s59
    s_lshr_b32 s15, s15, 16
    s_mul_i32 s59, s15, s79
    s_sub_u32 s14, s14, s59
    s_add_u32 s15, s15, 5
    s_lshl_b32 s15, s15, 7
    s_lshr_b32 s79, s79, 1
    s_add_u32 s79, s79, 4
    s_cmp_lt_u32 s14, s79
    s_cselect_b32 s6, s40, s42
    s_cselect_b32 s7, s41, s43
    s_cselect_b32 s59, 8, s79
    s_sub_u32 s59, s14, s59
    s_mul_i32 s79, s73, 5
    s_add_u32 s59, s59, s79
    s_and_b32 s79, s4, 6
    s_lshl2_add_u32 s79, s79, s14
    s_cmp_lt_u32 s14, 8
    s_cselect_b32 s6, s34, s6
    s_cselect_b32 s7, s35, s7
    s_cselect_b32 s14, s79, s59
    s_mul_i32 s14, s14, 73728
    s_add_u32 s14, s14, s15
    v_mul_u32_u24 v2, 1152, v1
    v_add_u32 v2, s14, v2
    global_load_dword v244, v2, s[6:7]
    v_and_b32 v31, 255, v0
    v_lshrrev_b32 v31, 2, v31
    v_and_b32 v32, 3, v0
    v_lshl_add_u32 v33, v31, 5, v32
    v_mul_u32_u24 v34, 1152, v33
    v_add_u32 v34, v35, v34
    v_lshrrev_b32 v36, 6, v0
    v_mul_u32_u24 v36, 5248, v36
    v_and_b32 v37, 15, v0
    v_lshl_add_u32 v36, v37, 4, v36
    v_bfe_u32 v37, v0, 4, 1
    v_mul_u32_u24 v37, 1280, v37
    v_add_u32 v36, v36, v37
    v_bfe_u32 v37, v0, 5, 1
    v_mul_u32_u24 v37, 2624, v37
    v_add_u32 v36, v36, v37
    v_mov_b32 v40, 0
    v_mov_b32 v41, 0
    v_mov_b32 v42, 0
    v_mov_b32 v43, 0
    s_cmp_ge_u32 s3, 6
    s_cbranch_scc1 L_noz_31
    ds_write_b128 v36, v[40:43] offset:0
L_noz_31:
    s_mul_i32 s14, s3, 16048
    s_add_u32 s58, s14, 31488
    s_add_u32 s68, s58, 11888
    s_mov_b32 s69, s58
    s_add_u32 s70, s58, 4160
    s_add_u32 s71, s58, 23680
    s_cmp_lt_u32 s3, 4
    s_cbranch_scc1 L_bases_32
    s_add_u32 s69, s58, 8256
    s_mov_b32 s68, s58
    s_bitcmp0_b32 s3, 0
    s_cbranch_scc1 L_bases_32
    s_add_u32 s68, s58, 11888
    s_sub_u32 s69, s58, 7792
    s_add_u32 s70, s58, 7632
    s_sub_u32 s71, s58, 11888
L_bases_32:
    v_lshlrev_b32 v36, 2, v1
    v_add_u32 v36, s58, v36
    v_and_b32 v7, 31, v1
    v_lshrrev_b32 v3, 5, v1
    v_mul_u32_u24 v37, 272, v7
    v_lshl_add_u32 v37, v3, 4, v37
    v_add_u32 v37, s58, v37
    s_lshl_b32 s14, s3, 2
    s_add_u32 s14, s14, 159872
    v_mov_b32 v2, s14
    ds_write_b32 v2, v40
    v_mov_b32 v64, 0
    v_mov_b32 v65, 0
    v_mov_b32 v66, 0
    v_mov_b32 v67, 0
    v_mov_b32 v68, 0
    v_mov_b32 v69, 0
    v_mov_b32 v70, 0
    v_mov_b32 v71, 0
    v_mov_b32 v72, 0
    v_mov_b32 v73, 0
    v_mov_b32 v74, 0
    v_mov_b32 v75, 0
    v_mov_b32 v76, 0
    v_mov_b32 v77, 0
    v_mov_b32 v78, 0
    v_mov_b32 v79, 0
    s_waitcnt vmcnt(3)
    v_mul_u32_u24 v2, 1152, v1
    s_and_b32 s14, s13, 31
    s_mul_i32 s14, s14, 73728
    s_lshr_b32 s15, s13, 5
    s_add_u32 s15, s15, s11
    s_cmp_gt_u32 s15, s72
    s_cselect_b32 s14, 2359296, s14
    s_lshl_b32 s15, s15, 7
    s_add_u32 s14, s14, s15
    buffer_load_dword v250, v2, s[60:63], s14 offen
    v_lshlrev_b32 v26, 16, v26
    v_mul_f32 v26, 1069066811, v26
    v_exp_f32 v26, v26
    s_nop 0
    v_cvt_pk_bf16_f32 v26, v26, v26
    v_lshlrev_b32 v26, 16, v26
    s_cmp_lt_u32 s3, 4
    s_cbranch_scc1 L_lo_33
    s_bitcmp0_b32 s3, 0
    s_cbranch_scc1 L_lo_33
    v_lshrrev_b32 v20, 16, v20
    v_lshrrev_b32 v21, 16, v21
    v_lshrrev_b32 v22, 16, v22
    v_lshrrev_b32 v23, 16, v23
    v_lshrrev_b32 v24, 16, v24
    v_lshrrev_b32 v25, 16, v25
L_lo_33:
    s_cmp_lt_u32 s3, 4
    s_cbranch_scc1 L_dopass_34
    s_cmp_lg_u32 s10, 1
    s_cbranch_scc1 L_dopass_34
    s_mov_b32 s15, 0
    buffer_load_dwordx3 v[224:226], v34, s[60:63], s15 offen
    s_mov_b32 s15, 4608
    buffer_load_dwordx3 v[228:230], v34, s[60:63], s15 offen
    s_mov_b32 s15, 9216
    buffer_load_dwordx3 v[232:234], v34, s[60:63], s15 offen
    s_mov_b32 s15, 13824
    buffer_load_dwordx3 v[236:238], v34, s[60:63], s15 offen
    s_mov_b32 s15, 18432
    buffer_load_dwordx3 v[240:242], v34, s[60:63], s15 offen
    s_mov_b32 s15, 23040
    buffer_load_dwordx3 v[244:246], v34, s[60:63], s15 offen
    s_mov_b32 s15, 27648
    buffer_load_dwordx3 v[248:250], v34, s[60:63], s15 offen
    s_mov_b32 s15, 32256
    buffer_load_dwordx3 v[252:254], v34, s[60:63], s15 offen
    s_branch L_passdone
L_dopass_34:
L_pass:
    v_lshlrev_b32 v46, 16, v20
    v_lshlrev_b32 v47, 16, v21
    v_lshlrev_b32 v48, 16, v22
    v_lshlrev_b32 v49, 16, v23
    v_lshlrev_b32 v50, 16, v24
    v_lshlrev_b32 v51, 16, v25
    v_lshrrev_b32 v20, 16, v20
    v_lshrrev_b32 v21, 16, v21
    v_lshrrev_b32 v22, 16, v22
    v_lshrrev_b32 v23, 16, v23
    v_lshrrev_b32 v24, 16, v24
    v_lshrrev_b32 v25, 16, v25
    v_mul_f32 v46, v26, v46
    v_mul_f32 v47, v26, v47
    v_mul_f32 v46, 1069066811, v46
    v_mul_f32 v47, 0.15915494, v47
    v_mul_f32 v54, 0x41000000, v46
    v_mul_f32 v55, 0x41000000, v47
    v_exp_f32 v54, v54
    v_fract_f32 v55, v55
    v_cos_f32 v42, v55
    v_sin_f32 v43, v55
    v_mul_f32 v42, v54, v42
    v_mul_f32 v43, v54, v43
    v_exp_f32 v52, v46
    v_fract_f32 v53, v47
    v_cos_f32 v40, v53
    v_sin_f32 v41, v53
    v_mul_f32 v40, v52, v40
    v_mul_f32 v41, v52, v41
    v_mul_f32 v54, 0x43800000, v46
    v_mul_f32 v55, 0x43800000, v47
    v_exp_f32 v54, v54
    v_fract_f32 v55, v55
    v_cos_f32 v44, v55
    v_sin_f32 v45, v55
    v_mul_f32 v44, v54, v44
    v_mul_f32 v45, v54, v45
    v_pk_mul_f32 v[52:53], v[50:51], v[48:49] op_sel:[0,0] op_sel_hi:[0,1]
    v_pk_fma_f32 v[52:53], v[50:51], v[48:49], v[52:53] op_sel:[1,1,0] op_sel_hi:[1,0,1] neg_lo:[0,1,0]
    v_mul_f32 v96, v26, v52
    v_mul_f32 v97, v26, v53
    v_cvt_pk_bf16_f32 v60, v96, -v97
    ds_write_b32 v36, v60 offset:0
    v_mov_b32 v61, 0x3f80
    ds_write_b32 v36, v61 offset:7344
    v_cvt_pk_bf16_f32 v62, v42, v43
    ds_write_b32 v36, v62 offset:7616
    v_pk_mul_f32 v[56:57], v[42:43], v[42:43] op_sel:[0,0] op_sel_hi:[0,1]
    v_pk_fma_f32 v[56:57], v[42:43], v[42:43], v[56:57] op_sel:[1,1,0] op_sel_hi:[1,0,1] neg_lo:[0,1,0]
    v_cvt_pk_bf16_f32 v63, v56, v57
    ds_write_b32 v36, v63 offset:7888
    v_pk_mul_f32 v[98:99], v[96:97], v[40:41] op_sel:[0,0] op_sel_hi:[0,1]
    v_pk_fma_f32 v[98:99], v[96:97], v[40:41], v[98:99] op_sel:[1,1,0] op_sel_hi:[1,0,1] neg_lo:[0,1,0]
    v_cvt_pk_bf16_f32 v60, v98, -v99
    ds_write_b32 v36, v60 offset:272
    v_pk_mul_f32 v[58:59], v[56:57], v[42:43] op_sel:[0,0] op_sel_hi:[0,1]
    v_pk_fma_f32 v[58:59], v[56:57], v[42:43], v[58:59] op_sel:[1,1,0] op_sel_hi:[1,0,1] neg_lo:[0,1,0]
    v_cvt_pk_bf16_f32 v61, v58, v59
    ds_write_b32 v36, v61 offset:8160
    v_pk_mul_f32 v[100:101], v[98:99], v[40:41] op_sel:[0,0] op_sel_hi:[0,1]
    v_pk_fma_f32 v[100:101], v[98:99], v[40:41], v[100:101] op_sel:[1,1,0] op_sel_hi:[1,0,1] neg_lo:[0,1,0]
    v_cvt_pk_bf16_f32 v62, v100, -v101
    ds_write_b32 v36, v62 offset:544
    s_cmp_lt_u32 s3, 4
    s_cbranch_scc1 L_nog_35
    s_mov_b32 s15, 0
    buffer_load_dwordx3 v[224:226], v34, s[60:63], s15 offen
    s_mov_b32 s15, 4608
    buffer_load_dwordx3 v[228:230], v34, s[60:63], s15 offen
L_nog_35:
    v_pk_mul_f32 v[56:57], v[58:59], v[42:43] op_sel:[0,0] op_sel_hi:[0,1]
    v_pk_fma_f32 v[56:57], v[58:59], v[42:43], v[56:57] op_sel:[1,1,0] op_sel_hi:[1,0,1] neg_lo:[0,1,0]
    v_cvt_pk_bf16_f32 v63, v56, v57
    ds_write_b32 v36, v63 offset:8432
    v_pk_mul_f32 v[102:103], v[100:101], v[40:41] op_sel:[0,0] op_sel_hi:[0,1]
    v_pk_fma_f32 v[102:103], v[100:101], v[40:41], v[102:103] op_sel:[1,1,0] op_sel_hi:[1,0,1] neg_lo:[0,1,0]
    v_cvt_pk_bf16_f32 v60, v102, -v103
    ds_write_b32 v36, v60 offset:816
    v_pk_mul_f32 v[58:59], v[56:57], v[42:43] op_sel:[0,0] op_sel_hi:[0,1]
    v_pk_fma_f32 v[58:59], v[56:57], v[42:43], v[58:59] op_sel:[1,1,0] op_sel_hi:[1,0,1] neg_lo:[0,1,0]
    v_cvt_pk_bf16_f32 v61, v58, v59
    ds_write_b32 v36, v61 offset:8704
    v_pk_mul_f32 v[104:105], v[102:103], v[40:41] op_sel:[0,0] op_sel_hi:[0,1]
    v_pk_fma_f32 v[104:105], v[102:103], v[40:41], v[104:105] op_sel:[1,1,0] op_sel_hi:[1,0,1] neg_lo:[0,1,0]
    v_cvt_pk_bf16_f32 v62, v104, -v105
    ds_write_b32 v36, v62 offset:2176
    v_pk_mul_f32 v[56:57], v[58:59], v[42:43] op_sel:[0,0] op_sel_hi:[0,1]
    v_pk_fma_f32 v[56:57], v[58:59], v[42:43], v[56:57] op_sel:[1,1,0] op_sel_hi:[1,0,1] neg_lo:[0,1,0]
    v_cvt_pk_bf16_f32 v63, v56, v57
    ds_write_b32 v36, v63 offset:8976
    v_pk_mul_f32 v[106:107], v[104:105], v[40:41] op_sel:[0,0] op_sel_hi:[0,1]
    v_pk_fma_f32 v[106:107], v[104:105], v[40:41], v[106:107] op_sel:[1,1,0] op_sel_hi:[1,0,1] neg_lo:[0,1,0]
    v_cvt_pk_bf16_f32 v60, v106, -v107
    ds_write_b32 v36, v60 offset:2448
    v_pk_mul_f32 v[58:59], v[56:57], v[42:43] op_sel:[0,0] op_sel_hi:[0,1]
    v_pk_fma_f32 v[58:59], v[56:57], v[42:43], v[58:59] op_sel:[1,1,0] op_sel_hi:[1,0,1] neg_lo:[0,1,0]
    v_cvt_pk_bf16_f32 v61, v58, v59
    ds_write_b32 v36, v61 offset:9248
    v_pk_mul_f32 v[108:109], v[106:107], v[40:41] op_sel:[0,0] op_sel_hi:[0,1]
    v_pk_fma_f32 v[108:109], v[106:107], v[40:41], v[108:109] op_sel:[1,1,0] op_sel_hi:[1,0,1] neg_lo:[0,1,0]
    v_cvt_pk_bf16_f32 v62, v108, -v109
    ds_write_b32 v36, v62 offset:2720
    v_pk_mul_f32 v[56:57], v[58:59], v[42:43] op_sel:[0,0] op_sel_hi:[0,1]
    v_pk_fma_f32 v[56:57], v[58:59], v[42:43], v[56:57] op_sel:[1,1,0] op_sel_hi:[1,0,1] neg_lo:[0,1,0]
    v_cvt_pk_bf16_f32 v63, v56, v57
    ds_write_b32 v36, v63 offset:9520
    v_pk_mul_f32 v[110:111], v[108:109], v[40:41] op_sel:[0,0] op_sel_hi:[0,1]
    v_pk_fma_f32 v[110:111], v[108:109], v[40:41], v[110:111] op_sel:[1,1,0] op_sel_hi:[1,0,1] neg_lo:[0,1,0]
    v_cvt_pk_bf16_f32 v60, v110, -v111
    ds_write_b32 v36, v60 offset:2992
    v_pk_mul_f32 v[58:59], v[56:57], v[42:43] op_sel:[0,0] op_sel_hi:[0,1]
    v_pk_fma_f32 v[58:59], v[56:57], v[42:43], v[58:59] op_sel:[1,1,0] op_sel_hi:[1,0,1] neg_lo:[0,1,0]
    v_cvt_pk_bf16_f32 v61, v58, v59
    ds_write_b32 v36, v61 offset:9792
    v_pk_mul_f32 v[112:113], v[110:111], v[40:41] op_sel:[0,0] op_sel_hi:[0,1]
    v_pk_fma_f32 v[112:113], v[110:111], v[40:41], v[112:113] op_sel:[1,1,0] op_sel_hi:[1,0,1] neg_lo:[0,1,0]
    v_pk_mul_f32 v[56:57], v[58:59], v[42:43] op_sel:[0,0] op_sel_hi:[0,1]
    v_pk_fma_f32 v[56:57], v[58:59], v[42:43], v[56:57] op_sel:[1,1,0] op_sel_hi:[1,0,1] neg_lo:[0,1,0]
    v_cvt_pk_bf16_f32 v62, v56, v57
    ds_write_b32 v36, v62 offset:10064
    v_pk_mul_f32 v[114:115], v[96:97], v[44:45] op_sel:[0,0] op_sel_hi:[0,1]
    v_pk_fma_f32 v[114:115], v[96:97], v[44:45], v[114:115] op_sel:[1,1,0] op_sel_hi:[1,0,1] neg_lo:[0,1,0]
    v_cvt_pk_bf16_f32 v63, v114, -v115
    ds_write_b32 v36, v63 offset:4352
    s_cmp_lt_u32 s3, 4
    s_cbranch_scc1 L_nog_36
    s_mov_b32 s15, 9216
    buffer_load_dwordx3 v[232:234], v34, s[60:63], s15 offen
    s_mov_b32 s15, 13824
    buffer_load_dwordx3 v[236:238], v34, s[60:63], s15 offen
L_nog_36:
    v_pk_mul_f32 v[58:59], v[56:57], v[42:43] op_sel:[0,0] op_sel_hi:[0,1]
    v_pk_fma_f32 v[58:59], v[56:57], v[42:43], v[58:59] op_sel:[1,1,0] op_sel_hi:[1,0,1] neg_lo:[0,1,0]
    v_cvt_pk_bf16_f32 v60, v58, v59
    ds_write_b32 v36, v60 offset:10336
    v_pk_mul_f32 v[116:117], v[114:115], v[44:45] op_sel:[0,0] op_sel_hi:[0,1]
    v_pk_fma_f32 v[116:117], v[114:115], v[44:45], v[116:117] op_sel:[1,1,0] op_sel_hi:[1,0,1] neg_lo:[0,1,0]
    v_cvt_pk_bf16_f32 v61, v116, -v117
    ds_write_b32 v36, v61 offset:1088
    v_pk_mul_f32 v[56:57], v[58:59], v[42:43] op_sel:[0,0] op_sel_hi:[0,1]
    v_pk_fma_f32 v[56:57], v[58:59], v[42:43], v[56:57] op_sel:[1,1,0] op_sel_hi:[1,0,1] neg_lo:[0,1,0]
    v_cvt_pk_bf16_f32 v62, v56, v57
    ds_write_b32 v36, v62 offset:10608
    v_pk_mul_f32 v[118:119], v[116:117], v[44:45] op_sel:[0,0] op_sel_hi:[0,1]
    v_pk_fma_f32 v[118:119], v[116:117], v[44:45], v[118:119] op_sel:[1,1,0] op_sel_hi:[1,0,1] neg_lo:[0,1,0]
    v_cvt_pk_bf16_f32 v63, v118, -v119
    ds_write_b32 v36, v63 offset:1904
    v_pk_mul_f32 v[58:59], v[56:57], v[42:43] op_sel:[0,0] op_sel_hi:[0,1]
    v_pk_fma_f32 v[58:59], v[56:57], v[42:43], v[58:59] op_sel:[1,1,0] op_sel_hi:[1,0,1] neg_lo:[0,1,0]
    v_cvt_pk_bf16_f32 v60, v58, v59
    ds_write_b32 v36, v60 offset:10880
    v_pk_mul_f32 v[120:121], v[118:119], v[44:45] op_sel:[0,0] op_sel_hi:[0,1]
    v_pk_fma_f32 v[120:121], v[118:119], v[44:45], v[120:121] op_sel:[1,1,0] op_sel_hi:[1,0,1] neg_lo:[0,1,0]
    v_cvt_pk_bf16_f32 v61, v120, -v121
    ds_write_b32 v36, v61 offset:6800
    v_pk_mul_f32 v[56:57], v[58:59], v[42:43] op_sel:[0,0] op_sel_hi:[0,1]
    v_pk_fma_f32 v[56:57], v[58:59], v[42:43], v[56:57] op_sel:[1,1,0] op_sel_hi:[1,0,1] neg_lo:[0,1,0]
    v_cvt_pk_bf16_f32 v62, v56, v57
    ds_write_b32 v36, v62 offset:11152
    v_pk_mul_f32 v[122:123], v[120:121], v[44:45] op_sel:[0,0] op_sel_hi:[0,1]
    v_pk_fma_f32 v[122:123], v[120:121], v[44:45], v[122:123] op_sel:[1,1,0] op_sel_hi:[1,0,1] neg_lo:[0,1,0]
    v_cvt_pk_bf16_f32 v63, v122, -v123
    ds_write_b32 v36, v63 offset:3808
    v_pk_mul_f32 v[58:59], v[56:57], v[42:43] op_sel:[0,0] op_sel_hi:[0,1]
    v_pk_fma_f32 v[58:59], v[56:57], v[42:43], v[58:59] op_sel:[1,1,0] op_sel_hi:[1,0,1] neg_lo:[0,1,0]
    v_cvt_pk_bf16_f32 v60, v58, v59
    ds_write_b32 v36, v60 offset:11424
    v_pk_mul_f32 v[124:125], v[122:123], v[44:45] op_sel:[0,0] op_sel_hi:[0,1]
    v_pk_fma_f32 v[124:125], v[122:123], v[44:45], v[124:125] op_sel:[1,1,0] op_sel_hi:[1,0,1] neg_lo:[0,1,0]
    v_cvt_pk_bf16_f32 v61, v124, -v125
    ds_write_b32 v36, v61 offset:5440
    v_pk_mul_f32 v[56:57], v[58:59], v[42:43] op_sel:[0,0] op_sel_hi:[0,1]
    v_pk_fma_f32 v[56:57], v[58:59], v[42:43], v[56:57] op_sel:[1,1,0] op_sel_hi:[1,0,1] neg_lo:[0,1,0]
    v_cvt_pk_bf16_f32 v62, v56, v57
    ds_write_b32 v36, v62 offset:11696
    v_pk_mul_f32 v[126:127], v[124:125], v[44:45] op_sel:[0,0] op_sel_hi:[0,1]
    v_pk_fma_f32 v[126:127], v[124:125], v[44:45], v[126:127] op_sel:[1,1,0] op_sel_hi:[1,0,1] neg_lo:[0,1,0]
    v_cvt_pk_bf16_f32 v63, v126, -v127
    ds_write_b32 v36, v63 offset:5984
    v_pk_mul_f32 v[58:59], v[56:57], v[42:43] op_sel:[0,0] op_sel_hi:[0,1]
    v_pk_fma_f32 v[58:59], v[56:57], v[42:43], v[58:59] op_sel:[1,1,0] op_sel_hi:[1,0,1] neg_lo:[0,1,0]
    v_cvt_pk_bf16_f32 v60, v58, v59
    ds_write_b32 v36, v60 offset:11968
    v_pk_mul_f32 v[128:129], v[112:113], v[44:45] op_sel:[0,0] op_sel_hi:[0,1]
    v_pk_fma_f32 v[128:129], v[112:113], v[44:45], v[128:129] op_sel:[1,1,0] op_sel_hi:[1,0,1] neg_lo:[0,1,0]
    v_cvt_pk_bf16_f32 v61, v128, -v129
    ds_write_b32 v36, v61 offset:6528
    s_cmp_lt_u32 s3, 4
    s_cbranch_scc1 L_nog_37
    s_mov_b32 s15, 18432
    buffer_load_dwordx3 v[240:242], v34, s[60:63], s15 offen
    s_mov_b32 s15, 23040
    buffer_load_dwordx3 v[244:246], v34, s[60:63], s15 offen
L_nog_37:
    v_pk_mul_f32 v[56:57], v[58:59], v[42:43] op_sel:[0,0] op_sel_hi:[0,1]
    v_pk_fma_f32 v[56:57], v[58:59], v[42:43], v[56:57] op_sel:[1,1,0] op_sel_hi:[1,0,1] neg_lo:[0,1,0]
    v_cvt_pk_bf16_f32 v62, v56, v57
    ds_write_b32 v36, v62 offset:12240
    v_pk_mul_f32 v[130:131], v[128:129], v[44:45] op_sel:[0,0] op_sel_hi:[0,1]
    v_pk_fma_f32 v[130:131], v[128:129], v[44:45], v[130:131] op_sel:[1,1,0] op_sel_hi:[1,0,1] neg_lo:[0,1,0]
    v_cvt_pk_bf16_f32 v63, v130, -v131
    ds_write_b32 v36, v63 offset:1632
    v_pk_mul_f32 v[58:59], v[56:57], v[42:43] op_sel:[0,0] op_sel_hi:[0,1]
    v_pk_fma_f32 v[58:59], v[56:57], v[42:43], v[58:59] op_sel:[1,1,0] op_sel_hi:[1,0,1] neg_lo:[0,1,0]
    v_cvt_pk_bf16_f32 v60, v58, v59
    ds_write_b32 v36, v60 offset:12512
    v_pk_mul_f32 v[132:133], v[130:131], v[44:45] op_sel:[0,0] op_sel_hi:[0,1]
    v_pk_fma_f32 v[132:133], v[130:131], v[44:45], v[132:133] op_sel:[1,1,0] op_sel_hi:[1,0,1] neg_lo:[0,1,0]
    v_cvt_pk_bf16_f32 v61, v132, -v133
    ds_write_b32 v36, v61 offset:3536
    v_pk_mul_f32 v[56:57], v[58:59], v[42:43] op_sel:[0,0] op_sel_hi:[0,1]
    v_pk_fma_f32 v[56:57], v[58:59], v[42:43], v[56:57] op_sel:[1,1,0] op_sel_hi:[1,0,1] neg_lo:[0,1,0]
    v_cvt_pk_bf16_f32 v62, v56, v57
    ds_write_b32 v36, v62 offset:12784
    v_pk_mul_f32 v[134:135], v[132:133], v[44:45] op_sel:[0,0] op_sel_hi:[0,1]
    v_pk_fma_f32 v[134:135], v[132:133], v[44:45], v[134:135] op_sel:[1,1,0] op_sel_hi:[1,0,1] neg_lo:[0,1,0]
    v_cvt_pk_bf16_f32 v63, v134, -v135
    ds_write_b32 v36, v63 offset:7072
    v_pk_mul_f32 v[58:59], v[56:57], v[42:43] op_sel:[0,0] op_sel_hi:[0,1]
    v_pk_fma_f32 v[58:59], v[56:57], v[42:43], v[58:59] op_sel:[1,1,0] op_sel_hi:[1,0,1] neg_lo:[0,1,0]
    v_cvt_pk_bf16_f32 v60, v58, v59
    ds_write_b32 v36, v60 offset:13056
    v_pk_mul_f32 v[136:137], v[134:135], v[44:45] op_sel:[0,0] op_sel_hi:[0,1]
    v_pk_fma_f32 v[136:137], v[134:135], v[44:45], v[136:137] op_sel:[1,1,0] op_sel_hi:[1,0,1] neg_lo:[0,1,0]
    v_cvt_pk_bf16_f32 v61, v136, -v137
    ds_write_b32 v36, v61 offset:4080
    v_pk_mul_f32 v[56:57], v[58:59], v[42:43] op_sel:[0,0] op_sel_hi:[0,1]
    v_pk_fma_f32 v[56:57], v[58:59], v[42:43], v[56:57] op_sel:[1,1,0] op_sel_hi:[1,0,1] neg_lo:[0,1,0]
    v_cvt_pk_bf16_f32 v62, v56, v57
    ds_write_b32 v36, v62 offset:13328
    v_pk_mul_f32 v[138:139], v[136:137], v[44:45] op_sel:[0,0] op_sel_hi:[0,1]
    v_pk_fma_f32 v[138:139], v[136:137], v[44:45], v[138:139] op_sel:[1,1,0] op_sel_hi:[1,0,1] neg_lo:[0,1,0]
    v_cvt_pk_bf16_f32 v63, v138, -v139
    ds_write_b32 v36, v63 offset:5712
    v_pk_mul_f32 v[58:59], v[56:57], v[42:43] op_sel:[0,0] op_sel_hi:[0,1]
    v_pk_fma_f32 v[58:59], v[56:57], v[42:43], v[58:59] op_sel:[1,1,0] op_sel_hi:[1,0,1] neg_lo:[0,1,0]
    v_cvt_pk_bf16_f32 v60, v58, v59
    ds_write_b32 v36, v60 offset:13600
    v_pk_mul_f32 v[140:141], v[138:139], v[44:45] op_sel:[0,0] op_sel_hi:[0,1]
    v_pk_fma_f32 v[140:141], v[138:139], v[44:45], v[140:141] op_sel:[1,1,0] op_sel_hi:[1,0,1] neg_lo:[0,1,0]
    v_cvt_pk_bf16_f32 v61, v140, -v141
    ds_write_b32 v36, v61 offset:6256
    v_pk_mul_f32 v[56:57], v[58:59], v[42:43] op_sel:[0,0] op_sel_hi:[0,1]
    v_pk_fma_f32 v[56:57], v[58:59], v[42:43], v[56:57] op_sel:[1,1,0] op_sel_hi:[1,0,1] neg_lo:[0,1,0]
    v_cvt_pk_bf16_f32 v62, v56, v57
    ds_write_b32 v36, v62 offset:13872
    v_pk_mul_f32 v[142:143], v[100:101], v[44:45] op_sel:[0,0] op_sel_hi:[0,1]
    v_pk_fma_f32 v[142:143], v[100:101], v[44:45], v[142:143] op_sel:[1,1,0] op_sel_hi:[1,0,1] neg_lo:[0,1,0]
    v_cvt_pk_bf16_f32 v63, v142, -v143
    ds_write_b32 v36, v63 offset:4624
    s_cmp_lt_u32 s3, 4
    s_cbranch_scc1 L_nog_38
    s_mov_b32 s15, 27648
    buffer_load_dwordx3 v[248:250], v34, s[60:63], s15 offen
    s_mov_b32 s15, 32256
    buffer_load_dwordx3 v[252:254], v34, s[60:63], s15 offen
L_nog_38:
    v_pk_mul_f32 v[58:59], v[56:57], v[42:43] op_sel:[0,0] op_sel_hi:[0,1]
    v_pk_fma_f32 v[58:59], v[56:57], v[42:43], v[58:59] op_sel:[1,1,0] op_sel_hi:[1,0,1] neg_lo:[0,1,0]
    v_cvt_pk_bf16_f32 v60, v58, v59
    ds_write_b32 v36, v60 offset:14144
    v_pk_mul_f32 v[144:145], v[104:105], v[44:45] op_sel:[0,0] op_sel_hi:[0,1]
    v_pk_fma_f32 v[144:145], v[104:105], v[44:45], v[144:145] op_sel:[1,1,0] op_sel_hi:[1,0,1] neg_lo:[0,1,0]
    v_cvt_pk_bf16_f32 v61, v144, -v145
    ds_write_b32 v36, v61 offset:4896
    v_pk_mul_f32 v[56:57], v[58:59], v[42:43] op_sel:[0,0] op_sel_hi:[0,1]
    v_pk_fma_f32 v[56:57], v[58:59], v[42:43], v[56:57] op_sel:[1,1,0] op_sel_hi:[1,0,1] neg_lo:[0,1,0]
    v_cvt_pk_bf16_f32 v62, v56, v57
    ds_write_b32 v36, v62 offset:14416
    v_pk_mul_f32 v[146:147], v[108:109], v[44:45] op_sel:[0,0] op_sel_hi:[0,1]
    v_pk_fma_f32 v[146:147], v[108:109], v[44:45], v[146:147] op_sel:[1,1,0] op_sel_hi:[1,0,1] neg_lo:[0,1,0]
    v_cvt_pk_bf16_f32 v63, v146, -v147
    ds_write_b32 v36, v63 offset:5168
    v_pk_mul_f32 v[58:59], v[56:57], v[42:43] op_sel:[0,0] op_sel_hi:[0,1]
    v_pk_fma_f32 v[58:59], v[56:57], v[42:43], v[58:59] op_sel:[1,1,0] op_sel_hi:[1,0,1] neg_lo:[0,1,0]
    v_cvt_pk_bf16_f32 v60, v58, v59
    ds_write_b32 v36, v60 offset:14688
    v_pk_mul_f32 v[148:149], v[144:145], v[44:45] op_sel:[0,0] op_sel_hi:[0,1]
    v_pk_fma_f32 v[148:149], v[144:145], v[44:45], v[148:149] op_sel:[1,1,0] op_sel_hi:[1,0,1] neg_lo:[0,1,0]
    v_cvt_pk_bf16_f32 v61, v148, -v149
    ds_write_b32 v36, v61 offset:1360
    v_pk_mul_f32 v[56:57], v[58:59], v[42:43] op_sel:[0,0] op_sel_hi:[0,1]
    v_pk_fma_f32 v[56:57], v[58:59], v[42:43], v[56:57] op_sel:[1,1,0] op_sel_hi:[1,0,1] neg_lo:[0,1,0]
    v_cvt_pk_bf16_f32 v62, v56, v57
    ds_write_b32 v36, v62 offset:14960
    v_pk_mul_f32 v[150:151], v[148:149], v[44:45] op_sel:[0,0] op_sel_hi:[0,1]
    v_pk_fma_f32 v[150:151], v[148:149], v[44:45], v[150:151] op_sel:[1,1,0] op_sel_hi:[1,0,1] neg_lo:[0,1,0]
    v_cvt_pk_bf16_f32 v63, v150, -v151
    ds_write_b32 v36, v63 offset:3264
    v_pk_mul_f32 v[58:59], v[56:57], v[42:43] op_sel:[0,0] op_sel_hi:[0,1]
    v_pk_fma_f32 v[58:59], v[56:57], v[42:43], v[58:59] op_sel:[1,1,0] op_sel_hi:[1,0,1] neg_lo:[0,1,0]
    v_cvt_pk_bf16_f32 v60, v58, v59
    ds_write_b32 v36, v60 offset:15232
    v_pk_mul_f32 v[56:57], v[58:59], v[42:43] op_sel:[0,0] op_sel_hi:[0,1]
    v_pk_fma_f32 v[56:57], v[58:59], v[42:43], v[56:57] op_sel:[1,1,0] op_sel_hi:[1,0,1] neg_lo:[0,1,0]
    v_cvt_pk_bf16_f32 v61, v56, v57
    ds_write_b32 v36, v61 offset:15504
    v_pk_mul_f32 v[58:59], v[56:57], v[42:43] op_sel:[0,0] op_sel_hi:[0,1]
    v_pk_fma_f32 v[58:59], v[56:57], v[42:43], v[58:59] op_sel:[1,1,0] op_sel_hi:[1,0,1] neg_lo:[0,1,0]
    v_cvt_pk_bf16_f32 v62, v58, v59
    ds_write_b32 v36, v62 offset:15776
    ds_read_b128 v[160:163], v37 offset:0
    ds_read_b128 v[164:167], v37 offset:7344
    ds_read_b128 v[168:171], v37 offset:32
    ds_read_b128 v[172:175], v37 offset:7376
    ds_read_b128 v[176:179], v37 offset:64
    ds_read_b128 v[180:183], v37 offset:7408
    ds_read_b128 v[184:187], v37 offset:96
    ds_read_b128 v[188:191], v37 offset:7440
    ds_read_b128 v[192:195], v37 offset:128
    ds_read_b128 v[196:199], v37 offset:7472
    ds_read_b128 v[200:203], v37 offset:160
    ds_read_b128 v[204:207], v37 offset:7504
    ds_read_b128 v[208:211], v37 offset:192
    ds_read_b128 v[212:215], v37 offset:7536
    ds_read_b128 v[216:219], v37 offset:224
    ds_read_b128 v[220:223], v37 offset:7568
    s_waitcnt lgkmcnt(14)
    v_mfma_f32_32x32x16_bf16 v[64:79], v[160:163], v[164:167], v[64:79]
    s_waitcnt lgkmcnt(12)
    v_mfma_f32_32x32x16_bf16 v[64:79], v[168:171], v[172:175], v[64:79]
    s_waitcnt lgkmcnt(10)
    v_mfma_f32_32x32x16_bf16 v[64:79], v[176:179], v[180:183], v[64:79]
    s_waitcnt lgkmcnt(8)
    v_mfma_f32_32x32x16_bf16 v[64:79], v[184:187], v[188:191], v[64:79]
    s_waitcnt lgkmcnt(6)
    v_mfma_f32_32x32x16_bf16 v[64:79], v[192:195], v[196:199], v[64:79]
    s_waitcnt lgkmcnt(4)
    v_mfma_f32_32x32x16_bf16 v[64:79], v[200:203], v[204:207], v[64:79]
    s_waitcnt lgkmcnt(2)
    v_mfma_f32_32x32x16_bf16 v[64:79], v[208:211], v[212:215], v[64:79]
    s_waitcnt lgkmcnt(0)
    v_mfma_f32_32x32x16_bf16 v[64:79], v[216:219], v[220:223], v[64:79]
    s_sub_u32 s12, s12, 1
    s_cmp_lg_u32 s12, 0
    s_cbranch_scc1 L_pass
L_passdone:
    v_lshrrev_b32 v2, 5, v1
    v_lshlrev_b32 v2, 6, v2
    v_bfe_u32 v3, v1, 2, 2
    v_lshl_add_u32 v2, v3, 3, v2
    v_and_b32 v3, 3, v1
    v_lshlrev_b32 v3, 3, v3
    v_sub_u32 v2, v3, v2
    v_bfe_u32 v3, v1, 4, 1
    v_lshl_add_u32 v2, v3, 5, v2
    s_add_u32 s14, s68, 88
    v_add_u32 v40, s14, v2
    v_mul_u32_u24 v41, 1280, v3
    v_and_b32 v2, 15, v1
    v_lshrrev_b32 v44, 5, v1
    v_add_u32 v42, v2, v44
    v_lshl_add_u32 v41, v42, 4, v41
    s_mul_i32 s14, s9, 5248
    s_add_u32 s14, s14, 0
    v_add_u32 v41, s14, v41
    v_lshrrev_b32 v42, 2, v2
    v_lshlrev_b32 v42, 1, v42
    v_lshl_add_u32 v42, v2, 3, v42
    v_lshl_add_u32 v42, v3, 2, v42
    v_add_u32 v42, v42, v44
    v_lshlrev_b32 v42, 2, v42
    v_add_u32 v42, s69, v42
    v_and_b32 v43, 51, v1
    v_cmp_eq_u32 vcc, 51, v43
    v_mov_b32 v43, 4
    v_mov_b32 v44, 12
    v_cndmask_b32 v43, v43, v44, vcc
    v_add_u32 v43, v43, v42
    v_cmp_eq_u32 vcc, 63, v1
    v_mov_b32 v37, 2200
    s_nop 0
    v_cndmask_b32 v37, 0, v37, vcc
    v_add_u32 v37, v37, v43
    v_lshlrev_b32 v39, 4, v1
    s_cmp_lt_u32 s3, 4
    s_cbranch_scc1 L_f1_39
    v_add_u32 v2, s70, v39
    ds_write_b128 v2, v[64:67] offset:0
    ds_write_b128 v2, v[68:71] offset:1024
    ds_write_b128 v2, v[72:75] offset:2048
    ds_write_b128 v2, v[76:79] offset:3072
    s_mov_b32 s6, 0x05040100
    s_mov_b32 s7, 0x07060302
    v_and_b32 v38, 1, v32
    v_mul_u32_u24 v38, 1280, v38
    v_lshl_add_u32 v38, v31, 4, v38
    v_lshrrev_b32 v3, 1, v32
    v_mul_u32_u24 v3, 2624, v3
    v_add_u32 v38, v38, v3
    s_waitcnt vmcnt(0)
    v_perm_b32 v96, v228, v224, s6
    v_perm_b32 v97, v236, v232, s6
    v_perm_b32 v98, v244, v240, s6
    v_perm_b32 v99, v252, v248, s6
    ds_write_b128 v38, v[96:99] offset:256
    v_perm_b32 v100, v228, v224, s7
    v_perm_b32 v101, v236, v232, s7
    v_perm_b32 v102, v244, v240, s7
    v_perm_b32 v103, v252, v248, s7
    ds_write_b128 v38, v[100:103] offset:5504
    v_perm_b32 v104, v229, v225, s6
    v_perm_b32 v105, v237, v233, s6
    v_perm_b32 v106, v245, v241, s6
    v_perm_b32 v107, v253, v249, s6
    ds_write_b128 v38, v[104:107] offset:10752
    v_perm_b32 v108, v229, v225, s7
    v_perm_b32 v109, v237, v233, s7
    v_perm_b32 v110, v245, v241, s7
    v_perm_b32 v111, v253, v249, s7
    ds_write_b128 v38, v[108:111] offset:16000
    v_perm_b32 v112, v230, v226, s6
    v_perm_b32 v113, v238, v234, s6
    v_perm_b32 v114, v246, v242, s6
    v_perm_b32 v115, v254, v250, s6
    ds_write_b128 v38, v[112:115] offset:21248
    v_perm_b32 v116, v230, v226, s7
    v_perm_b32 v117, v238, v234, s7
    v_perm_b32 v118, v246, v242, s7
    v_perm_b32 v119, v254, v250, s7
    ds_write_b128 v38, v[116:119] offset:26496
    s_waitcnt lgkmcnt(0)
    s_barrier
    s_setprio 1
    v_add_u32 v2, s71, v39
    ds_read_b128 v[96:99], v2 offset:0
    ds_read_b128 v[100:103], v2 offset:1024
    ds_read_b128 v[104:107], v2 offset:2048
    ds_read_b128 v[108:111], v2 offset:3072
    s_waitcnt lgkmcnt(0)
    v_add_f32 v64, v64, v96
    v_add_f32 v65, v65, v97
    v_add_f32 v66, v66, v98
    v_add_f32 v67, v67, v99
    v_add_f32 v68, v68, v100
    v_add_f32 v69, v69, v101
    v_add_f32 v70, v70, v102
    v_add_f32 v71, v71, v103
    v_add_f32 v72, v72, v104
    v_add_f32 v73, v73, v105
    v_add_f32 v74, v74, v106
    v_add_f32 v75, v75, v107
    v_add_f32 v76, v76, v108
    v_add_f32 v77, v77, v109
    v_add_f32 v78, v78, v110
L_f1_39:
    s_add_u32 s14, s68, 64
    v_lshl_add_u32 v2, v7, 4, s14
    v_and_b32 v3, 1, v1
    v_cmp_eq_u32 vcc, 1, v3
    s_mov_b32 exec_hi, 0
    v_cvt_pk_bf16_f32 v96, v64, v65
    v_cvt_pk_bf16_f32 v97, v66, v67
    v_cvt_pk_bf16_f32 v98, v68, v69
    v_cvt_pk_bf16_f32 v99, v70, v71
    ds_write_b128 v2, v[96:99] offset:0
    v_cvt_pk_bf16_f32 v104, v72, v72
    v_cvt_pk_bf16_f32 v105, v73, v74
    v_cvt_pk_bf16_f32 v106, v74, v74
    v_cvt_pk_bf16_f32 v107, v75, v76
    ds_write_b128 v2, v[104:107] offset:512
    v_cndmask_b32 v116, v77, v78, vcc
    v_cvt_pk_bf16_f32 v112, v77, v77
    v_cvt_pk_bf16_f32 v113, v77, v77
    v_cvt_pk_bf16_f32 v114, v116, v78
    v_cvt_pk_bf16_f32 v115, v78, v78
    ds_write_b128 v2, v[112:115] offset:2048
    s_mov_b32 exec_hi, -1
    s_mov_b32 exec_lo, 0
    v_cvt_pk_bf16_f32 v96, v64, v64
    v_cvt_pk_bf16_f32 v97, v64, v65
    v_cvt_pk_bf16_f32 v98, v65, v65
    v_cvt_pk_bf16_f32 v99, v66, v66
    ds_write_b128 v2, v[96:99] offset:1024
    v_cvt_pk_bf16_f32 v104, v67, v67
    v_cvt_pk_bf16_f32 v105, v67, v68
    v_cvt_pk_bf16_f32 v106, v68, v68
    v_cvt_pk_bf16_f32 v107, v69, v69
    ds_write_b128 v2, v[104:107] offset:1536
    v_cndmask_b32 v116, v70, v71, vcc
    v_cvt_pk_bf16_f32 v112, v70, v70
    v_cvt_pk_bf16_f32 v113, v70, v70
    v_cvt_pk_bf16_f32 v114, v116, v71
    v_cvt_pk_bf16_f32 v115, v71, v71
    ds_write_b128 v2, v[112:115] offset:2560
    v_cndmask_b32 v124, v72, v73, vcc
    v_cvt_pk_bf16_f32 v120, v72, v72
    v_cvt_pk_bf16_f32 v121, v72, v72
    v_cvt_pk_bf16_f32 v122, v124, v73
    v_cvt_pk_bf16_f32 v123, v73, v73
    ds_write_b128 v2, v[120:123] offset:3072
    v_cndmask_b32 v132, v74, v75, vcc
    v_cvt_pk_bf16_f32 v128, v74, v74
    v_cvt_pk_bf16_f32 v129, v74, v74
    v_cvt_pk_bf16_f32 v130, v132, v75
    v_cvt_pk_bf16_f32 v131, v75, v75
    ds_write_b128 v2, v[128:131] offset:3584
    s_mov_b32 exec_hi, 15
    v_mov_b32 v136, 0
    v_mov_b32 v137, 0
    v_mov_b32 v138, 0
    v_mov_b32 v139, 0
    v_subrev_u32 v2, 64, v2
    ds_write_b128 v2, v[136:139]
    s_mov_b32 exec_hi, 1
    v_mov_b32 v2, s69
    ds_write_b32 v2, v136 offset:4384
    ds_write_b32 v2, v136 offset:5480
    ds_write_b32 v2, v136 offset:6576
    s_mov_b64 exec, -1
    s_cmp_ge_u32 s3, 4
    s_cbranch_scc1 L_h0_40
    s_lshl_b32 s14, s3, 2
    s_add_u32 s14, s14, 159872
    v_mov_b32 v38, s14
    s_waitcnt vmcnt(0)
    s_barrier
    s_setprio 2
    ds_read_b64_tr_b16 v[48:49], v40 offset:40
    ds_read_b64_tr_b16 v[50:51], v40 offset:8
    ds_read_b128 v[96:99], v41 offset:240
    ds_read_b64_tr_b16 v[52:53], v40 offset:1064
    ds_read_b64_tr_b16 v[54:55], v40 offset:1032
    ds_read_b128 v[100:103], v41 offset:496
    ds_read_b128 v[104:107], v41 offset:2864
    ds_read_b128 v[108:111], v41 offset:3120
    ds_read_b128 v[112:115], v41 offset:208
    ds_read_b128 v[116:119], v41 offset:464
    s_waitcnt lgkmcnt(7)
    v_mfma_f32_32x32x16_bf16 v[128:143], v[48:51], v[96:99], 0
    s_waitcnt lgkmcnt(5)
    v_mfma_f32_32x32x16_bf16 v[160:175], v[52:55], v[96:99], 0
    ds_read_b128 v[120:123], v41 offset:2832
    ds_read_b64_tr_b16 v[64:65], v40 offset:168
    ds_read_b64_tr_b16 v[66:67], v40 offset:136
    s_waitcnt lgkmcnt(7)
    v_mfma_f32_32x32x16_bf16 v[160:175], v[48:51], v[100:103], v[160:175]
    ds_read_b128 v[124:127], v41 offset:3088
    ds_read_b64_tr_b16 v[68:69], v40 offset:1192
    ds_read_b64_tr_b16 v[70:71], v40 offset:1160
    s_waitcnt lgkmcnt(9)
    v_mfma_f32_32x32x16_bf16 v[144:159], v[48:51], v[104:107], 0
    v_mfma_f32_32x32x16_bf16 v[176:191], v[52:55], v[104:107], 0
    ds_read_b128 v[96:99], v41 offset:176
    s_waitcnt lgkmcnt(9)
    v_mfma_f32_32x32x16_bf16 v[176:191], v[48:51], v[108:111], v[176:191]
    ds_read_b128 v[100:103], v41 offset:432
    s_waitcnt lgkmcnt(9)
    s_waitcnt lgkmcnt(5)
    v_mfma_f32_32x32x16_bf16 v[128:143], v[64:67], v[112:115], v[128:143]
    s_waitcnt lgkmcnt(2)
    v_mfma_f32_32x32x16_bf16 v[160:175], v[68:71], v[112:115], v[160:175]
    ds_read_b128 v[104:107], v41 offset:2800
    ds_read_b64_tr_b16 v[48:49], v40 offset:296
    ds_read_b64_tr_b16 v[50:51], v40 offset:264
    v_mfma_f32_32x32x16_bf16 v[160:175], v[64:67], v[116:119], v[160:175]
    ds_read_b128 v[108:111], v41 offset:3056
    ds_read_b64_tr_b16 v[52:53], v40 offset:1320
    ds_read_b64_tr_b16 v[54:55], v40 offset:1288
    v_mfma_f32_32x32x16_bf16 v[144:159], v[64:67], v[120:123], v[144:159]
    v_mfma_f32_32x32x16_bf16 v[176:191], v[68:71], v[120:123], v[176:191]
    ds_read_b128 v[112:115], v41 offset:144
    v_mfma_f32_32x32x16_bf16 v[176:191], v[64:67], v[124:127], v[176:191]
    ds_read_b128 v[116:119], v41 offset:400
    s_waitcnt lgkmcnt(9)
    s_waitcnt lgkmcnt(5)
    v_mfma_f32_32x32x16_bf16 v[128:143], v[48:51], v[96:99], v[128:143]
    s_waitcnt lgkmcnt(2)
    v_mfma_f32_32x32x16_bf16 v[160:175], v[52:55], v[96:99], v[160:175]
    ds_read_b128 v[120:123], v41 offset:2768
    ds_read_b64_tr_b16 v[64:65], v40 offset:424
    ds_read_b64_tr_b16 v[66:67], v40 offset:392
    v_mfma_f32_32x32x16_bf16 v[160:175], v[48:51], v[100:103], v[160:175]
    ds_read_b128 v[124:127], v41 offset:3024
    ds_read_b64_tr_b16 v[68:69], v40 offset:1448
    ds_read_b64_tr_b16 v[70:71], v40 offset:1416
    v_mfma_f32_32x32x16_bf16 v[144:159], v[48:51], v[104:107], v[144:159]
    v_mfma_f32_32x32x16_bf16 v[176:191], v[52:55], v[104:107], v[176:191]
    ds_read_b128 v[96:99], v41 offset:112
    v_mfma_f32_32x32x16_bf16 v[176:191], v[48:51], v[108:111], v[176:191]
    ds_read_b128 v[100:103], v41 offset:368
    s_waitcnt lgkmcnt(9)
    s_waitcnt lgkmcnt(5)
    v_mfma_f32_32x32x16_bf16 v[128:143], v[64:67], v[112:115], v[128:143]
    s_waitcnt lgkmcnt(2)
    v_mfma_f32_32x32x16_bf16 v[160:175], v[68:71], v[112:115], v[160:175]
    ds_read_b128 v[104:107], v41 offset:2736
    ds_read_b64_tr_b16 v[48:49], v40 offset:552
    ds_read_b64_tr_b16 v[50:51], v40 offset:520
    v_mfma_f32_32x32x16_bf16 v[160:175], v[64:67], v[116:119], v[160:175]
    ds_read_b128 v[108:111], v41 offset:2992
    ds_read_b64_tr_b16 v[52:53], v40 offset:1576
    ds_read_b64_tr_b16 v[54:55], v40 offset:1544
    v_mfma_f32_32x32x16_bf16 v[144:159], v[64:67], v[120:123], v[144:159]
    v_mfma_f32_32x32x16_bf16 v[176:191], v[68:71], v[120:123], v[176:191]
    ds_read_b128 v[112:115], v41 offset:80
    v_mfma_f32_32x32x16_bf16 v[176:191], v[64:67], v[124:127], v[176:191]
    ds_read_b128 v[116:119], v41 offset:336
    s_waitcnt lgkmcnt(9)
    s_waitcnt lgkmcnt(5)
    v_mfma_f32_32x32x16_bf16 v[128:143], v[48:51], v[96:99], v[128:143]
    s_waitcnt lgkmcnt(2)
    v_mfma_f32_32x32x16_bf16 v[160:175], v[52:55], v[96:99], v[160:175]
    ds_read_b128 v[120:123], v41 offset:2704
    ds_read_b64_tr_b16 v[64:65], v40 offset:680
    ds_read_b64_tr_b16 v[66:67], v40 offset:648
    v_mfma_f32_32x32x16_bf16 v[160:175], v[48:51], v[100:103], v[160:175]
    ds_read_b128 v[124:127], v41 offset:2960
    ds_read_b64_tr_b16 v[68:69], v40 offset:1704
    ds_read_b64_tr_b16 v[70:71], v40 offset:1672
    v_mfma_f32_32x32x16_bf16 v[144:159], v[48:51], v[104:107], v[144:159]
    v_mfma_f32_32x32x16_bf16 v[176:191], v[52:55], v[104:107], v[176:191]
    ds_read_b128 v[96:99], v41 offset:48
    v_mfma_f32_32x32x16_bf16 v[176:191], v[48:51], v[108:111], v[176:191]
    ds_read_b128 v[100:103], v41 offset:304
    s_waitcnt lgkmcnt(9)
    s_waitcnt lgkmcnt(5)
    v_mfma_f32_32x32x16_bf16 v[128:143], v[64:67], v[112:115], v[128:143]
    s_waitcnt lgkmcnt(2)
    v_mfma_f32_32x32x16_bf16 v[160:175], v[68:71], v[112:115], v[160:175]
    ds_read_b128 v[104:107], v41 offset:2672
    ds_read_b64_tr_b16 v[48:49], v40 offset:808
    ds_read_b64_tr_b16 v[50:51], v40 offset:776
    v_mfma_f32_32x32x16_bf16 v[160:175], v[64:67], v[116:119], v[160:175]
    ds_read_b128 v[108:111], v41 offset:2928
    ds_read_b64_tr_b16 v[52:53], v40 offset:1832
    ds_read_b64_tr_b16 v[54:55], v40 offset:1800
    v_mfma_f32_32x32x16_bf16 v[144:159], v[64:67], v[120:123], v[144:159]
    v_mfma_f32_32x32x16_bf16 v[176:191], v[68:71], v[120:123], v[176:191]
    ds_read_b128 v[112:115], v41 offset:16
    v_mfma_f32_32x32x16_bf16 v[176:191], v[64:67], v[124:127], v[176:191]
    ds_read_b128 v[116:119], v41 offset:272
    s_waitcnt lgkmcnt(9)
    s_waitcnt lgkmcnt(5)
    v_mfma_f32_32x32x16_bf16 v[128:143], v[48:51], v[96:99], v[128:143]
    s_waitcnt lgkmcnt(2)
    v_mfma_f32_32x32x16_bf16 v[160:175], v[52:55], v[96:99], v[160:175]
    ds_read_b128 v[120:123], v41 offset:2640
    ds_read_b64_tr_b16 v[64:65], v40 offset:936
    ds_read_b64_tr_b16 v[66:67], v40 offset:904
    v_mfma_f32_32x32x16_bf16 v[160:175], v[48:51], v[100:103], v[160:175]
    ds_read_b128 v[124:127], v41 offset:2896
    ds_read_b64_tr_b16 v[68:69], v40 offset:1960
    ds_read_b64_tr_b16 v[70:71], v40 offset:1928
    v_mfma_f32_32x32x16_bf16 v[144:159], v[48:51], v[104:107], v[144:159]
    v_mfma_f32_32x32x16_bf16 v[176:191], v[52:55], v[104:107], v[176:191]
    v_mfma_f32_32x32x16_bf16 v[176:191], v[48:51], v[108:111], v[176:191]
    s_waitcnt lgkmcnt(7)
    s_waitcnt lgkmcnt(3)
    v_mfma_f32_32x32x16_bf16 v[128:143], v[64:67], v[112:115], v[128:143]
    s_waitcnt lgkmcnt(0)
    v_mfma_f32_32x32x16_bf16 v[160:175], v[68:71], v[112:115], v[160:175]
    v_mfma_f32_32x32x16_bf16 v[160:175], v[64:67], v[116:119], v[160:175]
    v_mfma_f32_32x32x16_bf16 v[144:159], v[64:67], v[120:123], v[144:159]
    v_mfma_f32_32x32x16_bf16 v[176:191], v[68:71], v[120:123], v[176:191]
    v_mfma_f32_32x32x16_bf16 v[176:191], v[64:67], v[124:127], v[176:191]
    ds_read_b64_tr_b16 v[48:49], v40 offset:40
    ds_read_b64_tr_b16 v[50:51], v40 offset:8
    ds_read_b128 v[96:99], v41 offset:240
    ds_read_b64_tr_b16 v[52:53], v40 offset:1064
    ds_read_b64_tr_b16 v[54:55], v40 offset:1032
    ds_read_b64_tr_b16 v[56:57], v40 offset:2088
    ds_read_b64_tr_b16 v[58:59], v40 offset:2056
    ds_read_b64_tr_b16 v[60:61], v40 offset:3112
    ds_read_b64_tr_b16 v[62:63], v40 offset:3080
    ds_read_b128 v[100:103], v41 offset:496
    ds_read_b128 v[104:107], v41 offset:752
    ds_read_b128 v[108:111], v41 offset:1008
    ds_read_b128 v[112:115], v41 offset:2864
    ds_read_b128 v[116:119], v41 offset:3120
    s_waitcnt lgkmcnt(11)
    s_waitcnt lgkmcnt(7)
    v_mfma_f32_32x32x16_bf16 v[192:207], v[56:59], v[96:99], 0
    s_waitcnt lgkmcnt(5)
    v_mfma_f32_32x32x16_bf16 v[224:239], v[60:63], v[96:99], 0
    ds_read_b128 v[120:123], v41 offset:3376
    ds_read_b64_tr_b16 v[64:65], v40 offset:168
    ds_read_b64_tr_b16 v[66:67], v40 offset:136
    s_waitcnt lgkmcnt(7)
    v_mfma_f32_32x32x16_bf16 v[192:207], v[52:55], v[100:103], v[192:207]
    v_mfma_f32_32x32x16_bf16 v[224:239], v[56:59], v[100:103], v[224:239]
    v_permlane16_swap_b32 v128, v136
    v_permlane16_swap_b32 v129, v137
    ds_read_b128 v[124:127], v41 offset:3632
    ds_read_b64_tr_b16 v[68:69], v40 offset:1192
    ds_read_b64_tr_b16 v[70:71], v40 offset:1160
    s_waitcnt lgkmcnt(9)
    v_mfma_f32_32x32x16_bf16 v[192:207], v[48:51], v[104:107], v[192:207]
    v_permlane16_swap_b32 v130, v138
    v_permlane16_swap_b32 v131, v139
    v_permlane16_swap_b32 v144, v152
    v_mfma_f32_32x32x16_bf16 v[224:239], v[52:55], v[104:107], v[224:239]
    v_permlane16_swap_b32 v145, v153
    v_permlane16_swap_b32 v146, v154
    v_permlane16_swap_b32 v147, v155
    ds_read_b128 v[96:99], v41 offset:208
    ds_read_b64_tr_b16 v[72:73], v40 offset:2216
    ds_read_b64_tr_b16 v[74:75], v40 offset:2184
    s_waitcnt lgkmcnt(11)
    v_mfma_f32_32x32x16_bf16 v[224:239], v[48:51], v[108:111], v[224:239]
    v_add_f32 v130, v130, v144
    v_add_f32 v131, v131, v145
    v_add_f32 v129, v129, v136
    ds_read_b128 v[100:103], v41 offset:464
    ds_read_b64_tr_b16 v[76:77], v40 offset:3240
    ds_read_b64_tr_b16 v[78:79], v40 offset:3208
    s_waitcnt lgkmcnt(13)
    v_mfma_f32_32x32x16_bf16 v[208:223], v[56:59], v[112:115], 0
    v_add_f32 v139, v139, v146
    v_add_f32 v147, v147, v154
    v_add_f32 v130, v130, v137
    v_mfma_f32_32x32x16_bf16 v[240:255], v[60:63], v[112:115], 0
    v_add_f32 v131, v131, v138
    v_add_f32 v139, v139, v153
    v_add_f32 v131, v131, v152
    ds_read_b128 v[104:107], v41 offset:720
    s_waitcnt lgkmcnt(13)
    v_mfma_f32_32x32x16_bf16 v[208:223], v[52:55], v[116:119], v[208:223]
    ds_write_b32 v42, v128 offset:0
    ds_write_b32 v42, v129 offset:1096
    ds_write_b32 v42, v130 offset:2192
    v_mfma_f32_32x32x16_bf16 v[240:255], v[56:59], v[116:119], v[240:255]
    ds_write_b32 v42, v131 offset:3288
    ds_write_b32 v42, v139 offset:4388
    ds_write_b32 v42, v147 offset:5484
    ds_read_b128 v[108:111], v41 offset:976
    s_waitcnt lgkmcnt(15)
    v_mfma_f32_32x32x16_bf16 v[208:223], v[48:51], v[120:123], v[208:223]
    ds_write_b32 v42, v155 offset:6580
    v_permlane16_swap_b32 v132, v140
    v_permlane16_swap_b32 v133, v141
    v_mfma_f32_32x32x16_bf16 v[240:255], v[52:55], v[120:123], v[240:255]
    v_permlane16_swap_b32 v134, v142
    v_permlane16_swap_b32 v135, v143
    v_permlane16_swap_b32 v148, v156
    ds_read_b128 v[112:115], v41 offset:2832
    s_waitcnt lgkmcnt(15)
    v_mfma_f32_32x32x16_bf16 v[240:255], v[48:51], v[124:127], v[240:255]
    v_permlane16_swap_b32 v149, v157
    v_permlane16_swap_b32 v150, v158
    v_permlane16_swap_b32 v151, v159
    ds_read_b128 v[116:119], v41 offset:3088
    s_waitcnt lgkmcnt(15)
    s_waitcnt lgkmcnt(14)
    v_mfma_f32_32x32x16_bf16 v[192:207], v[72:75], v[96:99], v[192:207]
    v_add_f32 v134, v134, v148
    v_add_f32 v135, v135, v149
    s_waitcnt lgkmcnt(11)
    v_mfma_f32_32x32x16_bf16 v[224:239], v[76:79], v[96:99], v[224:239]
    v_add_f32 v133, v133, v140
    v_add_f32 v143, v143, v150
    v_add_f32 v151, v151, v158
    ds_read_b128 v[120:123], v41 offset:3344
    ds_read_b64_tr_b16 v[48:49], v40 offset:296
    ds_read_b64_tr_b16 v[50:51], v40 offset:264
    v_mfma_f32_32x32x16_bf16 v[192:207], v[68:71], v[100:103], v[192:207]
    v_add_f32 v134, v134, v141
    v_add_f32 v135, v135, v142
    v_add_f32 v143, v143, v157
    v_mfma_f32_32x32x16_bf16 v[224:239], v[72:75], v[100:103], v[224:239]
    v_add_f32 v135, v135, v156
    ds_write_b32 v42, v132 offset:8
    ds_write_b32 v42, v133 offset:1104
    ds_read_b128 v[124:127], v41 offset:3600
    ds_read_b64_tr_b16 v[52:53], v40 offset:1320
    ds_read_b64_tr_b16 v[54:55], v40 offset:1288
    s_waitcnt lgkmcnt(15)
    v_mfma_f32_32x32x16_bf16 v[192:207], v[64:67], v[104:107], v[192:207]
    ds_write_b32 v42, v134 offset:2200
    ds_write_b32 v42, v135 offset:3296
    ds_write_b32 v43, v143 offset:4392
    v_mfma_f32_32x32x16_bf16 v[224:239], v[68:71], v[104:107], v[224:239]
    ds_write_b32 v43, v151 offset:5488
    ds_write_b32 v43, v159 offset:6584
    v_permlane16_swap_b32 v160, v168
    ds_read_b128 v[96:99], v41 offset:176
    ds_read_b64_tr_b16 v[56:57], v40 offset:2344
    ds_read_b64_tr_b16 v[58:59], v40 offset:2312
    s_waitcnt lgkmcnt(15)
    v_mfma_f32_32x32x16_bf16 v[224:239], v[64:67], v[108:111], v[224:239]
    v_permlane16_swap_b32 v161, v169
    v_permlane16_swap_b32 v162, v170
    v_permlane16_swap_b32 v163, v171
    ds_read_b128 v[100:103], v41 offset:432
    ds_read_b64_tr_b16 v[60:61], v40 offset:3368
    ds_read_b64_tr_b16 v[62:63], v40 offset:3336
    s_waitcnt lgkmcnt(15)
    v_mfma_f32_32x32x16_bf16 v[208:223], v[72:75], v[112:115], v[208:223]
    v_permlane16_swap_b32 v176, v184
    v_permlane16_swap_b32 v177, v185
    v_permlane16_swap_b32 v178, v186
    v_mfma_f32_32x32x16_bf16 v[240:255], v[76:79], v[112:115], v[240:255]
    v_permlane16_swap_b32 v179, v187
    v_add_f32 v162, v162, v176
    v_add_f32 v163, v163, v177
    ds_read_b128 v[104:107], v41 offset:688
    s_waitcnt lgkmcnt(15)
    v_mfma_f32_32x32x16_bf16 v[208:223], v[68:71], v[116:119], v[208:223]
    v_add_f32 v161, v161, v168
    v_add_f32 v171, v171, v178
    v_add_f32 v179, v179, v186
    v_mfma_f32_32x32x16_bf16 v[240:255], v[72:75], v[116:119], v[240:255]
    v_add_f32 v162, v162, v169
    v_add_f32 v163, v163, v170
    v_add_f32 v171, v171, v185
    ds_read_b128 v[108:111], v41 offset:944
    s_waitcnt lgkmcnt(15)
    v_mfma_f32_32x32x16_bf16 v[208:223], v[64:67], v[120:123], v[208:223]
    v_add_f32 v163, v163, v184
    ds_write_b32 v42, v160 offset:544
    v_mfma_f32_32x32x16_bf16 v[240:255], v[68:71], v[120:123], v[240:255]
    ds_write_b32 v42, v161 offset:1640
    ds_write_b32 v42, v162 offset:2736
    ds_write_b32 v42, v163 offset:3832
    ds_read_b128 v[112:115], v41 offset:2800
    s_waitcnt lgkmcnt(15)
    v_mfma_f32_32x32x16_bf16 v[240:255], v[64:67], v[124:127], v[240:255]
    ds_write_b32 v42, v171 offset:4932
    ds_write_b32 v42, v179 offset:6028
    ds_write_b32 v42, v187 offset:7124
    ds_read_b128 v[116:119], v41 offset:3056
    s_waitcnt lgkmcnt(15)
    s_waitcnt lgkmcnt(14)
    v_mfma_f32_32x32x16_bf16 v[192:207], v[56:59], v[96:99], v[192:207]
    v_permlane16_swap_b32 v164, v172
    v_permlane16_swap_b32 v165, v173
    v_permlane16_swap_b32 v166, v174
    s_waitcnt lgkmcnt(11)
    v_mfma_f32_32x32x16_bf16 v[224:239], v[60:63], v[96:99], v[224:239]
    v_permlane16_swap_b32 v167, v175
    v_permlane16_swap_b32 v180, v188
    v_permlane16_swap_b32 v181, v189
    ds_read_b128 v[120:123], v41 offset:3312
    ds_read_b64_tr_b16 v[64:65], v40 offset:424
    ds_read_b64_tr_b16 v[66:67], v40 offset:392
    v_mfma_f32_32x32x16_bf16 v[192:207], v[52:55], v[100:103], v[192:207]
    v_permlane16_swap_b32 v182, v190
    v_permlane16_swap_b32 v183, v191
    v_add_f32 v166, v166, v180
    v_mfma_f32_32x32x16_bf16 v[224:239], v[56:59], v[100:103], v[224:239]
    v_add_f32 v167, v167, v181
    v_add_f32 v165, v165, v172
    v_add_f32 v175, v175, v182
    ds_read_b128 v[124:127], v41 offset:3568
    ds_read_b64_tr_b16 v[68:69], v40 offset:1448
    ds_read_b64_tr_b16 v[70:71], v40 offset:1416
    s_waitcnt lgkmcnt(15)
    v_mfma_f32_32x32x16_bf16 v[192:207], v[48:51], v[104:107], v[192:207]
    v_add_f32 v183, v183, v190
    v_add_f32 v166, v166, v173
    v_add_f32 v167, v167, v174
    v_mfma_f32_32x32x16_bf16 v[224:239], v[52:55], v[104:107], v[224:239]
    v_add_f32 v175, v175, v189
    v_add_f32 v167, v167, v188
    ds_write_b32 v42, v164 offset:552
    ds_read_b128 v[96:99], v41 offset:144
    ds_read_b64_tr_b16 v[72:73], v40 offset:2472
    ds_read_b64_tr_b16 v[74:75], v40 offset:2440
    s_waitcnt lgkmcnt(15)
    v_mfma_f32_32x32x16_bf16 v[224:239], v[48:51], v[108:111], v[224:239]
    ds_write_b32 v42, v165 offset:1648
    ds_write_b32 v42, v166 offset:2744
    ds_write_b32 v42, v167 offset:3840
    ds_read_b128 v[100:103], v41 offset:400
    ds_read_b64_tr_b16 v[76:77], v40 offset:3496
    ds_read_b64_tr_b16 v[78:79], v40 offset:3464
    s_waitcnt lgkmcnt(15)
    v_mfma_f32_32x32x16_bf16 v[208:223], v[56:59], v[112:115], v[208:223]
    ds_write_b32 v37, v175 offset:4936
    ds_write_b32 v37, v183 offset:6032
    ds_write_b32 v37, v191 offset:7128
    v_mov_b32 v45, 1
    ds_write_b32 v38, v45
    s_setprio 0
    v_mfma_f32_32x32x16_bf16 v[240:255], v[60:63], v[112:115], v[240:255]
    ds_read_b128 v[104:107], v41 offset:656
    s_waitcnt lgkmcnt(15)
    v_mfma_f32_32x32x16_bf16 v[208:223], v[52:55], v[116:119], v[208:223]
    v_mfma_f32_32x32x16_bf16 v[240:255], v[56:59], v[116:119], v[240:255]
    ds_read_b128 v[108:111], v41 offset:912
    s_waitcnt lgkmcnt(15)
    v_mfma_f32_32x32x16_bf16 v[208:223], v[48:51], v[120:123], v[208:223]
    v_mfma_f32_32x32x16_bf16 v[240:255], v[52:55], v[120:123], v[240:255]
    ds_read_b128 v[112:115], v41 offset:2768
    s_waitcnt lgkmcnt(15)
    v_mfma_f32_32x32x16_bf16 v[240:255], v[48:51], v[124:127], v[240:255]
    ds_read_b128 v[116:119], v41 offset:3024
    s_waitcnt lgkmcnt(15)
    s_waitcnt lgkmcnt(14)
    v_mfma_f32_32x32x16_bf16 v[192:207], v[72:75], v[96:99], v[192:207]
    s_waitcnt lgkmcnt(8)
    v_mfma_f32_32x32x16_bf16 v[224:239], v[76:79], v[96:99], v[224:239]
    ds_read_b128 v[120:123], v41 offset:3280
    ds_read_b64_tr_b16 v[48:49], v40 offset:552
    ds_read_b64_tr_b16 v[50:51], v40 offset:520
    v_mfma_f32_32x32x16_bf16 v[192:207], v[68:71], v[100:103], v[192:207]
    v_mfma_f32_32x32x16_bf16 v[224:239], v[72:75], v[100:103], v[224:239]
    ds_read_b128 v[124:127], v41 offset:3536
    ds_read_b64_tr_b16 v[52:53], v40 offset:1576
    ds_read_b64_tr_b16 v[54:55], v40 offset:1544
    s_waitcnt lgkmcnt(9)
    v_mfma_f32_32x32x16_bf16 v[192:207], v[64:67], v[104:107], v[192:207]
    v_mfma_f32_32x32x16_bf16 v[224:239], v[68:71], v[104:107], v[224:239]
    ds_read_b128 v[96:99], v41 offset:112
    ds_read_b64_tr_b16 v[56:57], v40 offset:2600
    ds_read_b64_tr_b16 v[58:59], v40 offset:2568
    s_waitcnt lgkmcnt(11)
    v_mfma_f32_32x32x16_bf16 v[224:239], v[64:67], v[108:111], v[224:239]
    ds_read_b128 v[100:103], v41 offset:368
    ds_read_b64_tr_b16 v[60:61], v40 offset:3624
    ds_read_b64_tr_b16 v[62:63], v40 offset:3592
    s_waitcnt lgkmcnt(13)
    v_mfma_f32_32x32x16_bf16 v[208:223], v[72:75], v[112:115], v[208:223]
    v_mfma_f32_32x32x16_bf16 v[240:255], v[76:79], v[112:115], v[240:255]
    ds_read_b128 v[104:107], v41 offset:624
    s_waitcnt lgkmcnt(13)
    v_mfma_f32_32x32x16_bf16 v[208:223], v[68:71], v[116:119], v[208:223]
    v_mfma_f32_32x32x16_bf16 v[240:255], v[72:75], v[116:119], v[240:255]
    ds_read_b128 v[108:111], v41 offset:880
    s_waitcnt lgkmcnt(13)
    v_mfma_f32_32x32x16_bf16 v[208:223], v[64:67], v[120:123], v[208:223]
    v_mfma_f32_32x32x16_bf16 v[240:255], v[68:71], v[120:123], v[240:255]
    ds_read_b128 v[112:115], v41 offset:2736
    s_waitcnt lgkmcnt(11)
    v_mfma_f32_32x32x16_bf16 v[240:255], v[64:67], v[124:127], v[240:255]
    ds_read_b128 v[116:119], v41 offset:2992
    s_waitcnt lgkmcnt(9)
    s_waitcnt lgkmcnt(7)
    v_mfma_f32_32x32x16_bf16 v[192:207], v[56:59], v[96:99], v[192:207]
    s_waitcnt lgkmcnt(4)
    v_mfma_f32_32x32x16_bf16 v[224:239], v[60:63], v[96:99], v[224:239]
    ds_read_b128 v[120:123], v41 offset:3248
    ds_read_b64_tr_b16 v[64:65], v40 offset:680
    ds_read_b64_tr_b16 v[66:67], v40 offset:648
    v_mfma_f32_32x32x16_bf16 v[192:207], v[52:55], v[100:103], v[192:207]
    v_mfma_f32_32x32x16_bf16 v[224:239], v[56:59], v[100:103], v[224:239]
    ds_read_b128 v[124:127], v41 offset:3504
    ds_read_b64_tr_b16 v[68:69], v40 offset:1704
    ds_read_b64_tr_b16 v[70:71], v40 offset:1672
    s_waitcnt lgkmcnt(9)
    v_mfma_f32_32x32x16_bf16 v[192:207], v[48:51], v[104:107], v[192:207]
    v_mfma_f32_32x32x16_bf16 v[224:239], v[52:55], v[104:107], v[224:239]
    ds_read_b128 v[96:99], v41 offset:80
    ds_read_b64_tr_b16 v[72:73], v40 offset:2728
    ds_read_b64_tr_b16 v[74:75], v40 offset:2696
    s_waitcnt lgkmcnt(11)
    v_mfma_f32_32x32x16_bf16 v[224:239], v[48:51], v[108:111], v[224:239]
    ds_read_b128 v[100:103], v41 offset:336
    ds_read_b64_tr_b16 v[76:77], v40 offset:3752
    ds_read_b64_tr_b16 v[78:79], v40 offset:3720
    s_waitcnt lgkmcnt(13)
    v_mfma_f32_32x32x16_bf16 v[208:223], v[56:59], v[112:115], v[208:223]
    v_mfma_f32_32x32x16_bf16 v[240:255], v[60:63], v[112:115], v[240:255]
    ds_read_b128 v[104:107], v41 offset:592
    s_waitcnt lgkmcnt(13)
    v_mfma_f32_32x32x16_bf16 v[208:223], v[52:55], v[116:119], v[208:223]
    v_mfma_f32_32x32x16_bf16 v[240:255], v[56:59], v[116:119], v[240:255]
    ds_read_b128 v[108:111], v41 offset:848
    s_waitcnt lgkmcnt(13)
    v_mfma_f32_32x32x16_bf16 v[208:223], v[48:51], v[120:123], v[208:223]
    v_mfma_f32_32x32x16_bf16 v[240:255], v[52:55], v[120:123], v[240:255]
    ds_read_b128 v[112:115], v41 offset:2704
    s_waitcnt lgkmcnt(11)
    v_mfma_f32_32x32x16_bf16 v[240:255], v[48:51], v[124:127], v[240:255]
    ds_read_b128 v[116:119], v41 offset:2960
    s_waitcnt lgkmcnt(9)
    s_waitcnt lgkmcnt(7)
    v_mfma_f32_32x32x16_bf16 v[192:207], v[72:75], v[96:99], v[192:207]
    s_waitcnt lgkmcnt(4)
    v_mfma_f32_32x32x16_bf16 v[224:239], v[76:79], v[96:99], v[224:239]
    ds_read_b128 v[120:123], v41 offset:3216
    ds_read_b64_tr_b16 v[48:49], v40 offset:808
    ds_read_b64_tr_b16 v[50:51], v40 offset:776
    v_mfma_f32_32x32x16_bf16 v[192:207], v[68:71], v[100:103], v[192:207]
    v_mfma_f32_32x32x16_bf16 v[224:239], v[72:75], v[100:103], v[224:239]
    ds_read_b128 v[124:127], v41 offset:3472
    ds_read_b64_tr_b16 v[52:53], v40 offset:1832
    ds_read_b64_tr_b16 v[54:55], v40 offset:1800
    s_waitcnt lgkmcnt(9)
    v_mfma_f32_32x32x16_bf16 v[192:207], v[64:67], v[104:107], v[192:207]
    v_mfma_f32_32x32x16_bf16 v[224:239], v[68:71], v[104:107], v[224:239]
    ds_read_b128 v[96:99], v41 offset:48
    ds_read_b64_tr_b16 v[56:57], v40 offset:2856
    ds_read_b64_tr_b16 v[58:59], v40 offset:2824
    s_waitcnt lgkmcnt(11)
    v_mfma_f32_32x32x16_bf16 v[224:239], v[64:67], v[108:111], v[224:239]
    ds_read_b128 v[100:103], v41 offset:304
    ds_read_b64_tr_b16 v[60:61], v40 offset:3880
    ds_read_b64_tr_b16 v[62:63], v40 offset:3848
    s_waitcnt lgkmcnt(13)
    v_mfma_f32_32x32x16_bf16 v[208:223], v[72:75], v[112:115], v[208:223]
    v_mfma_f32_32x32x16_bf16 v[240:255], v[76:79], v[112:115], v[240:255]
    ds_read_b128 v[104:107], v41 offset:560
    s_waitcnt lgkmcnt(13)
    v_mfma_f32_32x32x16_bf16 v[208:223], v[68:71], v[116:119], v[208:223]
    v_mfma_f32_32x32x16_bf16 v[240:255], v[72:75], v[116:119], v[240:255]
    ds_read_b128 v[108:111], v41 offset:816
    s_waitcnt lgkmcnt(13)
    v_mfma_f32_32x32x16_bf16 v[208:223], v[64:67], v[120:123], v[208:223]
    v_mfma_f32_32x32x16_bf16 v[240:255], v[68:71], v[120:123], v[240:255]
    ds_read_b128 v[112:115], v41 offset:2672
    s_waitcnt lgkmcnt(11)
    v_mfma_f32_32x32x16_bf16 v[240:255], v[64:67], v[124:127], v[240:255]
    ds_read_b128 v[116:119], v41 offset:2928
    s_waitcnt lgkmcnt(9)
    s_waitcnt lgkmcnt(7)
    v_mfma_f32_32x32x16_bf16 v[192:207], v[56:59], v[96:99], v[192:207]
    s_waitcnt lgkmcnt(4)
    v_mfma_f32_32x32x16_bf16 v[224:239], v[60:63], v[96:99], v[224:239]
    ds_read_b128 v[120:123], v41 offset:3184
    ds_read_b64_tr_b16 v[64:65], v40 offset:936
    ds_read_b64_tr_b16 v[66:67], v40 offset:904
    v_mfma_f32_32x32x16_bf16 v[192:207], v[52:55], v[100:103], v[192:207]
    v_mfma_f32_32x32x16_bf16 v[224:239], v[56:59], v[100:103], v[224:239]
    ds_read_b128 v[124:127], v41 offset:3440
    ds_read_b64_tr_b16 v[68:69], v40 offset:1960
    ds_read_b64_tr_b16 v[70:71], v40 offset:1928
    s_waitcnt lgkmcnt(9)
    v_mfma_f32_32x32x16_bf16 v[192:207], v[48:51], v[104:107], v[192:207]
    v_mfma_f32_32x32x16_bf16 v[224:239], v[52:55], v[104:107], v[224:239]
    ds_read_b128 v[96:99], v41 offset:16
    ds_read_b64_tr_b16 v[72:73], v40 offset:2984
    ds_read_b64_tr_b16 v[74:75], v40 offset:2952
    s_waitcnt lgkmcnt(11)
    v_mfma_f32_32x32x16_bf16 v[224:239], v[48:51], v[108:111], v[224:239]
    ds_read_b128 v[100:103], v41 offset:272
    ds_read_b64_tr_b16 v[76:77], v40 offset:4008
    ds_read_b64_tr_b16 v[78:79], v40 offset:3976
    s_waitcnt lgkmcnt(13)
    v_mfma_f32_32x32x16_bf16 v[208:223], v[56:59], v[112:115], v[208:223]
    v_mfma_f32_32x32x16_bf16 v[240:255], v[60:63], v[112:115], v[240:255]
    ds_read_b128 v[104:107], v41 offset:528
    s_waitcnt lgkmcnt(13)
    v_mfma_f32_32x32x16_bf16 v[208:223], v[52:55], v[116:119], v[208:223]
    v_mfma_f32_32x32x16_bf16 v[240:255], v[56:59], v[116:119], v[240:255]
    ds_read_b128 v[108:111], v41 offset:784
    s_waitcnt lgkmcnt(13)
    v_mfma_f32_32x32x16_bf16 v[208:223], v[48:51], v[120:123], v[208:223]
    v_mfma_f32_32x32x16_bf16 v[240:255], v[52:55], v[120:123], v[240:255]
    ds_read_b128 v[112:115], v41 offset:2640
    s_waitcnt lgkmcnt(11)
    v_mfma_f32_32x32x16_bf16 v[240:255], v[48:51], v[124:127], v[240:255]
    ds_read_b128 v[116:119], v41 offset:2896
    s_waitcnt lgkmcnt(9)
    s_waitcnt lgkmcnt(7)
    v_mfma_f32_32x32x16_bf16 v[192:207], v[72:75], v[96:99], v[192:207]
    s_waitcnt lgkmcnt(4)
    v_mfma_f32_32x32x16_bf16 v[224:239], v[76:79], v[96:99], v[224:239]
    ds_read_b128 v[120:123], v41 offset:3152
    v_mfma_f32_32x32x16_bf16 v[192:207], v[68:71], v[100:103], v[192:207]
    v_mfma_f32_32x32x16_bf16 v[224:239], v[72:75], v[100:103], v[224:239]
    ds_read_b128 v[124:127], v41 offset:3408
    s_waitcnt lgkmcnt(5)
    v_mfma_f32_32x32x16_bf16 v[192:207], v[64:67], v[104:107], v[192:207]
    v_mfma_f32_32x32x16_bf16 v[224:239], v[68:71], v[104:107], v[224:239]
    s_waitcnt lgkmcnt(4)
    v_mfma_f32_32x32x16_bf16 v[224:239], v[64:67], v[108:111], v[224:239]
    s_waitcnt lgkmcnt(3)
    v_mfma_f32_32x32x16_bf16 v[208:223], v[72:75], v[112:115], v[208:223]
    v_mfma_f32_32x32x16_bf16 v[240:255], v[76:79], v[112:115], v[240:255]
    s_waitcnt lgkmcnt(2)
    v_mfma_f32_32x32x16_bf16 v[208:223], v[68:71], v[116:119], v[208:223]
    v_mfma_f32_32x32x16_bf16 v[240:255], v[72:75], v[116:119], v[240:255]
    s_waitcnt lgkmcnt(1)
    v_mfma_f32_32x32x16_bf16 v[208:223], v[64:67], v[120:123], v[208:223]
    v_mfma_f32_32x32x16_bf16 v[240:255], v[68:71], v[120:123], v[240:255]
    s_waitcnt lgkmcnt(0)
    v_mfma_f32_32x32x16_bf16 v[240:255], v[64:67], v[124:127], v[240:255]
    v_permlane16_swap_b32 v192, v200
    v_permlane16_swap_b32 v193, v201
    v_permlane16_swap_b32 v194, v202
    v_permlane16_swap_b32 v195, v203
    s_nop 4
    v_permlane16_swap_b32 v208, v216
    v_permlane16_swap_b32 v209, v217
    v_permlane16_swap_b32 v210, v218
    v_permlane16_swap_b32 v211, v219
    v_add_f32 v194, v194, v208
    v_add_f32 v195, v195, v209
    v_add_f32 v193, v193, v200
    v_add_f32 v203, v203, v210
    v_add_f32 v211, v211, v218
    v_add_f32 v194, v194, v201
    v_add_f32 v195, v195, v202
    v_add_f32 v203, v203, v217
    v_add_f32 v195, v195, v216
    ds_write_b32 v42, v192 offset:10960
    ds_write_b32 v42, v193 offset:12056
    ds_write_b32 v42, v194 offset:13152
    ds_write_b32 v42, v195 offset:14248
    ds_write_b32 v42, v203 offset:7676
    ds_write_b32 v42, v211 offset:8772
    ds_write_b32 v42, v219 offset:9868
    v_permlane16_swap_b32 v196, v204
    v_permlane16_swap_b32 v197, v205
    v_permlane16_swap_b32 v198, v206
    v_permlane16_swap_b32 v199, v207
    v_permlane16_swap_b32 v212, v220
    v_permlane16_swap_b32 v213, v221
    v_permlane16_swap_b32 v214, v222
    v_permlane16_swap_b32 v215, v223
    v_add_f32 v198, v198, v212
    v_add_f32 v199, v199, v213
    v_add_f32 v197, v197, v204
    v_add_f32 v207, v207, v214
    v_add_f32 v215, v215, v222
    v_add_f32 v198, v198, v205
    v_add_f32 v199, v199, v206
    v_add_f32 v207, v207, v221
    v_add_f32 v199, v199, v220
    ds_write_b32 v42, v196 offset:10968
    ds_write_b32 v42, v197 offset:12064
    ds_write_b32 v42, v198 offset:13160
    ds_write_b32 v42, v199 offset:14256
    ds_write_b32 v43, v207 offset:7680
    ds_write_b32 v43, v215 offset:8776
    ds_write_b32 v43, v223 offset:9872
    v_permlane16_swap_b32 v224, v232
    v_permlane16_swap_b32 v225, v233
    v_permlane16_swap_b32 v226, v234
    v_permlane16_swap_b32 v227, v235
    v_permlane16_swap_b32 v240, v248
    v_permlane16_swap_b32 v241, v249
    v_permlane16_swap_b32 v242, v250
    v_permlane16_swap_b32 v243, v251
    v_add_f32 v226, v226, v240
    v_add_f32 v227, v227, v241
    v_add_f32 v225, v225, v232
    v_add_f32 v235, v235, v242
    v_add_f32 v243, v243, v250
    v_add_f32 v226, v226, v233
    v_add_f32 v227, v227, v234
    v_add_f32 v235, v235, v249
    v_add_f32 v227, v227, v248
    ds_write_b32 v42, v224 offset:11504
    ds_write_b32 v42, v225 offset:12600
    ds_write_b32 v42, v226 offset:13696
    ds_write_b32 v42, v227 offset:14792
    ds_write_b32 v42, v235 offset:8220
    ds_write_b32 v42, v243 offset:9316
    ds_write_b32 v42, v251 offset:10412
    v_permlane16_swap_b32 v228, v236
    v_permlane16_swap_b32 v229, v237
    v_permlane16_swap_b32 v230, v238
    v_permlane16_swap_b32 v231, v239
    v_permlane16_swap_b32 v244, v252
    v_permlane16_swap_b32 v245, v253
    v_permlane16_swap_b32 v246, v254
    v_permlane16_swap_b32 v247, v255
    v_add_f32 v230, v230, v244
    v_add_f32 v231, v231, v245
    v_add_f32 v229, v229, v236
    v_add_f32 v239, v239, v246
    v_add_f32 v247, v247, v254
    v_add_f32 v230, v230, v237
    v_add_f32 v231, v231, v238
    v_add_f32 v239, v239, v253
    v_add_f32 v231, v231, v252
    ds_write_b32 v42, v228 offset:11512
    ds_write_b32 v42, v229 offset:12608
    ds_write_b32 v42, v230 offset:13704
    ds_write_b32 v42, v231 offset:14800
    ds_write_b32 v43, v239 offset:8224
    ds_write_b32 v43, v247 offset:9320
    ds_write_b32 v43, v255 offset:10416
    s_branch L_ce_43
L_h0_40:
    s_lshl_b32 s14, s3, 2
    s_add_u32 s14, s14, 159872
    v_mov_b32 v38, s14
    v_mov_b32 v39, 159872
    s_cmp_eq_u32 s10, 1
    s_cbranch_scc1 L_he_42
    s_bitcmp1_b32 s3, 0
    s_cbranch_scc1 L_h1_41
    ds_read_b64_tr_b16 v[48:49], v40 offset:40
    ds_read_b64_tr_b16 v[50:51], v40 offset:8
    ds_read_b128 v[96:99], v41 offset:240
    ds_read_b64_tr_b16 v[52:53], v40 offset:1064
    ds_read_b64_tr_b16 v[54:55], v40 offset:1032
    ds_read_b64_tr_b16 v[56:57], v40 offset:2088
    ds_read_b64_tr_b16 v[58:59], v40 offset:2056
    ds_read_b64_tr_b16 v[60:61], v40 offset:3112
    ds_read_b64_tr_b16 v[62:63], v40 offset:3080
    ds_read_b128 v[100:103], v41 offset:496
    ds_read_b128 v[104:107], v41 offset:752
    ds_read_b128 v[108:111], v41 offset:1008
    ds_read_b128 v[112:115], v41 offset:2864
    ds_read_b128 v[116:119], v41 offset:3120
    s_waitcnt lgkmcnt(11)
    v_mfma_f32_32x32x16_bf16 v[128:143], v[48:51], v[96:99], 0
    s_waitcnt lgkmcnt(5)
    v_mfma_f32_32x32x16_bf16 v[224:239], v[60:63], v[96:99], 0
    ds_read_b128 v[120:123], v41 offset:3376
    ds_read_b64_tr_b16 v[64:65], v40 offset:168
    ds_read_b64_tr_b16 v[66:67], v40 offset:136
    s_waitcnt lgkmcnt(7)
    v_mfma_f32_32x32x16_bf16 v[224:239], v[56:59], v[100:103], v[224:239]
    ds_read_b128 v[124:127], v41 offset:3632
    ds_read_b64_tr_b16 v[68:69], v40 offset:1192
    ds_read_b64_tr_b16 v[70:71], v40 offset:1160
    s_waitcnt lgkmcnt(9)
    v_mfma_f32_32x32x16_bf16 v[224:239], v[52:55], v[104:107], v[224:239]
    ds_read_b128 v[96:99], v41 offset:208
    ds_read_b64_tr_b16 v[72:73], v40 offset:2216
    ds_read_b64_tr_b16 v[74:75], v40 offset:2184
    s_waitcnt lgkmcnt(11)
    v_mfma_f32_32x32x16_bf16 v[224:239], v[48:51], v[108:111], v[224:239]
    ds_read_b128 v[100:103], v41 offset:464
    ds_read_b64_tr_b16 v[76:77], v40 offset:3240
    ds_read_b64_tr_b16 v[78:79], v40 offset:3208
    s_waitcnt lgkmcnt(13)
    v_mfma_f32_32x32x16_bf16 v[144:159], v[48:51], v[112:115], 0
    v_mfma_f32_32x32x16_bf16 v[240:255], v[60:63], v[112:115], 0
    ds_read_b128 v[104:107], v41 offset:720
    s_waitcnt lgkmcnt(13)
    v_mfma_f32_32x32x16_bf16 v[240:255], v[56:59], v[116:119], v[240:255]
    ds_read_b128 v[108:111], v41 offset:976
    s_waitcnt lgkmcnt(13)
    v_mfma_f32_32x32x16_bf16 v[240:255], v[52:55], v[120:123], v[240:255]
    ds_read_b128 v[112:115], v41 offset:2832
    s_waitcnt lgkmcnt(11)
    v_mfma_f32_32x32x16_bf16 v[240:255], v[48:51], v[124:127], v[240:255]
    ds_read_b128 v[116:119], v41 offset:3088
    s_waitcnt lgkmcnt(9)
    v_mfma_f32_32x32x16_bf16 v[128:143], v[64:67], v[96:99], v[128:143]
    s_waitcnt lgkmcnt(4)
    v_mfma_f32_32x32x16_bf16 v[224:239], v[76:79], v[96:99], v[224:239]
    ds_read_b128 v[120:123], v41 offset:3344
    ds_read_b64_tr_b16 v[48:49], v40 offset:296
    ds_read_b64_tr_b16 v[50:51], v40 offset:264
    v_mfma_f32_32x32x16_bf16 v[224:239], v[72:75], v[100:103], v[224:239]
    ds_read_b128 v[124:127], v41 offset:3600
    ds_read_b64_tr_b16 v[52:53], v40 offset:1320
    ds_read_b64_tr_b16 v[54:55], v40 offset:1288
    s_waitcnt lgkmcnt(9)
    v_mfma_f32_32x32x16_bf16 v[224:239], v[68:71], v[104:107], v[224:239]
    ds_read_b128 v[96:99], v41 offset:176
    ds_read_b64_tr_b16 v[56:57], v40 offset:2344
    ds_read_b64_tr_b16 v[58:59], v40 offset:2312
    s_waitcnt lgkmcnt(11)
    v_mfma_f32_32x32x16_bf16 v[224:239], v[64:67], v[108:111], v[224:239]
    ds_read_b128 v[100:103], v41 offset:432
    ds_read_b64_tr_b16 v[60:61], v40 offset:3368
    ds_read_b64_tr_b16 v[62:63], v40 offset:3336
    s_waitcnt lgkmcnt(13)
    v_mfma_f32_32x32x16_bf16 v[144:159], v[64:67], v[112:115], v[144:159]
    v_mfma_f32_32x32x16_bf16 v[240:255], v[76:79], v[112:115], v[240:255]
    ds_read_b128 v[104:107], v41 offset:688
    s_waitcnt lgkmcnt(13)
    v_mfma_f32_32x32x16_bf16 v[240:255], v[72:75], v[116:119], v[240:255]
    ds_read_b128 v[108:111], v41 offset:944
    s_waitcnt lgkmcnt(13)
    v_mfma_f32_32x32x16_bf16 v[240:255], v[68:71], v[120:123], v[240:255]
    ds_read_b128 v[112:115], v41 offset:2800
    s_waitcnt lgkmcnt(11)
    v_mfma_f32_32x32x16_bf16 v[240:255], v[64:67], v[124:127], v[240:255]
    ds_read_b128 v[116:119], v41 offset:3056
    s_waitcnt lgkmcnt(9)
    v_mfma_f32_32x32x16_bf16 v[128:143], v[48:51], v[96:99], v[128:143]
    s_waitcnt lgkmcnt(4)
    v_mfma_f32_32x32x16_bf16 v[224:239], v[60:63], v[96:99], v[224:239]
    ds_read_b128 v[120:123], v41 offset:3312
    ds_read_b64_tr_b16 v[64:65], v40 offset:424
    ds_read_b64_tr_b16 v[66:67], v40 offset:392
    v_mfma_f32_32x32x16_bf16 v[224:239], v[56:59], v[100:103], v[224:239]
    ds_read_b128 v[124:127], v41 offset:3568
    ds_read_b64_tr_b16 v[68:69], v40 offset:1448
    ds_read_b64_tr_b16 v[70:71], v40 offset:1416
    s_waitcnt lgkmcnt(9)
    v_mfma_f32_32x32x16_bf16 v[224:239], v[52:55], v[104:107], v[224:239]
    ds_read_b128 v[96:99], v41 offset:144
    ds_read_b64_tr_b16 v[72:73], v40 offset:2472
    ds_read_b64_tr_b16 v[74:75], v40 offset:2440
    s_waitcnt lgkmcnt(11)
    v_mfma_f32_32x32x16_bf16 v[224:239], v[48:51], v[108:111], v[224:239]
    ds_read_b128 v[100:103], v41 offset:400
    ds_read_b64_tr_b16 v[76:77], v40 offset:3496
    ds_read_b64_tr_b16 v[78:79], v40 offset:3464
    s_waitcnt lgkmcnt(13)
    v_mfma_f32_32x32x16_bf16 v[144:159], v[48:51], v[112:115], v[144:159]
    v_mfma_f32_32x32x16_bf16 v[240:255], v[60:63], v[112:115], v[240:255]
    ds_read_b128 v[104:107], v41 offset:656
    s_waitcnt lgkmcnt(13)
    v_mfma_f32_32x32x16_bf16 v[240:255], v[56:59], v[116:119], v[240:255]
    ds_read_b128 v[108:111], v41 offset:912
    s_waitcnt lgkmcnt(13)
    v_mfma_f32_32x32x16_bf16 v[240:255], v[52:55], v[120:123], v[240:255]
    ds_read_b128 v[112:115], v41 offset:2768
    s_waitcnt lgkmcnt(11)
    v_mfma_f32_32x32x16_bf16 v[240:255], v[48:51], v[124:127], v[240:255]
    ds_read_b128 v[116:119], v41 offset:3024
    s_waitcnt lgkmcnt(9)
    v_mfma_f32_32x32x16_bf16 v[128:143], v[64:67], v[96:99], v[128:143]
    s_waitcnt lgkmcnt(4)
    v_mfma_f32_32x32x16_bf16 v[224:239], v[76:79], v[96:99], v[224:239]
    ds_read_b128 v[120:123], v41 offset:3280
    ds_read_b64_tr_b16 v[48:49], v40 offset:552
    ds_read_b64_tr_b16 v[50:51], v40 offset:520
    v_mfma_f32_32x32x16_bf16 v[224:239], v[72:75], v[100:103], v[224:239]
    ds_read_b128 v[124:127], v41 offset:3536
    ds_read_b64_tr_b16 v[52:53], v40 offset:1576
    ds_read_b64_tr_b16 v[54:55], v40 offset:1544
    s_waitcnt lgkmcnt(9)
    v_mfma_f32_32x32x16_bf16 v[224:239], v[68:71], v[104:107], v[224:239]
    ds_read_b128 v[96:99], v41 offset:112
    ds_read_b64_tr_b16 v[56:57], v40 offset:2600
    ds_read_b64_tr_b16 v[58:59], v40 offset:2568
    s_waitcnt lgkmcnt(11)
    v_mfma_f32_32x32x16_bf16 v[224:239], v[64:67], v[108:111], v[224:239]
    ds_read_b128 v[100:103], v41 offset:368
    ds_read_b64_tr_b16 v[60:61], v40 offset:3624
    ds_read_b64_tr_b16 v[62:63], v40 offset:3592
    s_waitcnt lgkmcnt(13)
    v_mfma_f32_32x32x16_bf16 v[144:159], v[64:67], v[112:115], v[144:159]
    v_mfma_f32_32x32x16_bf16 v[240:255], v[76:79], v[112:115], v[240:255]
    ds_read_b128 v[104:107], v41 offset:624
    s_waitcnt lgkmcnt(13)
    v_mfma_f32_32x32x16_bf16 v[240:255], v[72:75], v[116:119], v[240:255]
    ds_read_b128 v[108:111], v41 offset:880
    s_waitcnt lgkmcnt(13)
    v_mfma_f32_32x32x16_bf16 v[240:255], v[68:71], v[120:123], v[240:255]
    ds_read_b128 v[112:115], v41 offset:2736
    s_waitcnt lgkmcnt(11)
    v_mfma_f32_32x32x16_bf16 v[240:255], v[64:67], v[124:127], v[240:255]
    ds_read_b128 v[116:119], v41 offset:2992
    s_waitcnt lgkmcnt(9)
    v_mfma_f32_32x32x16_bf16 v[128:143], v[48:51], v[96:99], v[128:143]
    s_waitcnt lgkmcnt(4)
    v_mfma_f32_32x32x16_bf16 v[224:239], v[60:63], v[96:99], v[224:239]
    ds_read_b128 v[120:123], v41 offset:3248
    ds_read_b64_tr_b16 v[64:65], v40 offset:680
    ds_read_b64_tr_b16 v[66:67], v40 offset:648
    v_mfma_f32_32x32x16_bf16 v[224:239], v[56:59], v[100:103], v[224:239]
    ds_read_b128 v[124:127], v41 offset:3504
    ds_read_b64_tr_b16 v[68:69], v40 offset:1704
    ds_read_b64_tr_b16 v[70:71], v40 offset:1672
    s_waitcnt lgkmcnt(9)
    v_mfma_f32_32x32x16_bf16 v[224:239], v[52:55], v[104:107], v[224:239]
    ds_read_b128 v[96:99], v41 offset:80
    ds_read_b64_tr_b16 v[72:73], v40 offset:2728
    ds_read_b64_tr_b16 v[74:75], v40 offset:2696
    s_waitcnt lgkmcnt(11)
    v_mfma_f32_32x32x16_bf16 v[224:239], v[48:51], v[108:111], v[224:239]
    ds_read_b128 v[100:103], v41 offset:336
    ds_read_b64_tr_b16 v[76:77], v40 offset:3752
    ds_read_b64_tr_b16 v[78:79], v40 offset:3720
    s_waitcnt lgkmcnt(13)
    v_mfma_f32_32x32x16_bf16 v[144:159], v[48:51], v[112:115], v[144:159]
    v_mfma_f32_32x32x16_bf16 v[240:255], v[60:63], v[112:115], v[240:255]
    ds_read_b128 v[104:107], v41 offset:592
    s_waitcnt lgkmcnt(13)
    v_mfma_f32_32x32x16_bf16 v[240:255], v[56:59], v[116:119], v[240:255]
    ds_read_b128 v[108:111], v41 offset:848
    s_waitcnt lgkmcnt(13)
    v_mfma_f32_32x32x16_bf16 v[240:255], v[52:55], v[120:123], v[240:255]
    ds_read_b128 v[112:115], v41 offset:2704
    s_waitcnt lgkmcnt(11)
    v_mfma_f32_32x32x16_bf16 v[240:255], v[48:51], v[124:127], v[240:255]
    ds_read_b128 v[116:119], v41 offset:2960
    s_waitcnt lgkmcnt(9)
    v_mfma_f32_32x32x16_bf16 v[128:143], v[64:67], v[96:99], v[128:143]
    s_waitcnt lgkmcnt(4)
    v_mfma_f32_32x32x16_bf16 v[224:239], v[76:79], v[96:99], v[224:239]
    ds_read_b128 v[120:123], v41 offset:3216
    ds_read_b64_tr_b16 v[48:49], v40 offset:808
    ds_read_b64_tr_b16 v[50:51], v40 offset:776
    v_mfma_f32_32x32x16_bf16 v[224:239], v[72:75], v[100:103], v[224:239]
    ds_read_b128 v[124:127], v41 offset:3472
    ds_read_b64_tr_b16 v[52:53], v40 offset:1832
    ds_read_b64_tr_b16 v[54:55], v40 offset:1800
    s_waitcnt lgkmcnt(9)
    v_mfma_f32_32x32x16_bf16 v[224:239], v[68:71], v[104:107], v[224:239]
    ds_read_b128 v[96:99], v41 offset:48
    ds_read_b64_tr_b16 v[56:57], v40 offset:2856
    ds_read_b64_tr_b16 v[58:59], v40 offset:2824
    s_waitcnt lgkmcnt(11)
    v_mfma_f32_32x32x16_bf16 v[224:239], v[64:67], v[108:111], v[224:239]
    ds_read_b128 v[100:103], v41 offset:304
    ds_read_b64_tr_b16 v[60:61], v40 offset:3880
    ds_read_b64_tr_b16 v[62:63], v40 offset:3848
    s_waitcnt lgkmcnt(13)
    v_mfma_f32_32x32x16_bf16 v[144:159], v[64:67], v[112:115], v[144:159]
    v_mfma_f32_32x32x16_bf16 v[240:255], v[76:79], v[112:115], v[240:255]
    ds_read_b128 v[104:107], v41 offset:560
    s_waitcnt lgkmcnt(13)
    v_mfma_f32_32x32x16_bf16 v[240:255], v[72:75], v[116:119], v[240:255]
    ds_read_b128 v[108:111], v41 offset:816
    s_waitcnt lgkmcnt(13)
    v_mfma_f32_32x32x16_bf16 v[240:255], v[68:71], v[120:123], v[240:255]
    ds_read_b128 v[112:115], v41 offset:2672
    s_waitcnt lgkmcnt(11)
    v_mfma_f32_32x32x16_bf16 v[240:255], v[64:67], v[124:127], v[240:255]
    ds_read_b128 v[116:119], v41 offset:2928
    s_waitcnt lgkmcnt(9)
    v_mfma_f32_32x32x16_bf16 v[128:143], v[48:51], v[96:99], v[128:143]
    s_waitcnt lgkmcnt(4)
    v_mfma_f32_32x32x16_bf16 v[224:239], v[60:63], v[96:99], v[224:239]
    ds_read_b128 v[120:123], v41 offset:3184
    ds_read_b64_tr_b16 v[64:65], v40 offset:936
    ds_read_b64_tr_b16 v[66:67], v40 offset:904
    v_mfma_f32_32x32x16_bf16 v[224:239], v[56:59], v[100:103], v[224:239]
    ds_read_b128 v[124:127], v41 offset:3440
    ds_read_b64_tr_b16 v[68:69], v40 offset:1960
    ds_read_b64_tr_b16 v[70:71], v40 offset:1928
    s_waitcnt lgkmcnt(9)
    v_mfma_f32_32x32x16_bf16 v[224:239], v[52:55], v[104:107], v[224:239]
    ds_read_b128 v[96:99], v41 offset:16
    ds_read_b64_tr_b16 v[72:73], v40 offset:2984
    ds_read_b64_tr_b16 v[74:75], v40 offset:2952
    s_waitcnt lgkmcnt(11)
    v_mfma_f32_32x32x16_bf16 v[224:239], v[48:51], v[108:111], v[224:239]
    ds_read_b128 v[100:103], v41 offset:272
    ds_read_b64_tr_b16 v[76:77], v40 offset:4008
    ds_read_b64_tr_b16 v[78:79], v40 offset:3976
    s_waitcnt lgkmcnt(13)
    v_mfma_f32_32x32x16_bf16 v[144:159], v[48:51], v[112:115], v[144:159]
    v_mfma_f32_32x32x16_bf16 v[240:255], v[60:63], v[112:115], v[240:255]
    ds_read_b128 v[104:107], v41 offset:528
    s_waitcnt lgkmcnt(13)
    v_mfma_f32_32x32x16_bf16 v[240:255], v[56:59], v[116:119], v[240:255]
    ds_read_b128 v[108:111], v41 offset:784
    s_waitcnt lgkmcnt(13)
    v_mfma_f32_32x32x16_bf16 v[240:255], v[52:55], v[120:123], v[240:255]
    ds_read_b128 v[112:115], v41 offset:2640
    s_waitcnt lgkmcnt(11)
    v_mfma_f32_32x32x16_bf16 v[240:255], v[48:51], v[124:127], v[240:255]
    ds_read_b128 v[116:119], v41 offset:2896
    s_waitcnt lgkmcnt(9)
    v_mfma_f32_32x32x16_bf16 v[128:143], v[64:67], v[96:99], v[128:143]
    s_waitcnt lgkmcnt(4)
    v_mfma_f32_32x32x16_bf16 v[224:239], v[76:79], v[96:99], v[224:239]
    ds_read_b128 v[120:123], v41 offset:3152
    v_mfma_f32_32x32x16_bf16 v[224:239], v[72:75], v[100:103], v[224:239]
    ds_read_b128 v[124:127], v41 offset:3408
    s_waitcnt lgkmcnt(5)
    v_mfma_f32_32x32x16_bf16 v[224:239], v[68:71], v[104:107], v[224:239]
    s_waitcnt lgkmcnt(4)
    v_mfma_f32_32x32x16_bf16 v[224:239], v[64:67], v[108:111], v[224:239]
    s_waitcnt lgkmcnt(3)
    v_mfma_f32_32x32x16_bf16 v[144:159], v[64:67], v[112:115], v[144:159]
    v_mfma_f32_32x32x16_bf16 v[240:255], v[76:79], v[112:115], v[240:255]
    s_waitcnt lgkmcnt(2)
    v_mfma_f32_32x32x16_bf16 v[240:255], v[72:75], v[116:119], v[240:255]
    s_waitcnt lgkmcnt(1)
    v_mfma_f32_32x32x16_bf16 v[240:255], v[68:71], v[120:123], v[240:255]
    s_waitcnt lgkmcnt(0)
    v_mfma_f32_32x32x16_bf16 v[240:255], v[64:67], v[124:127], v[240:255]
    v_permlane16_swap_b32 v128, v136
    v_permlane16_swap_b32 v129, v137
    v_permlane16_swap_b32 v130, v138
    v_permlane16_swap_b32 v131, v139
    s_nop 0
    v_permlane16_swap_b32 v144, v152
    v_permlane16_swap_b32 v145, v153
    v_permlane16_swap_b32 v146, v154
    v_permlane16_swap_b32 v147, v155
    v_add_f32 v130, v130, v144
    v_add_f32 v131, v131, v145
    v_add_f32 v129, v129, v136
    v_add_f32 v139, v139, v146
    v_add_f32 v147, v147, v154
    v_add_f32 v130, v130, v137
    v_add_f32 v131, v131, v138
    v_add_f32 v139, v139, v153
    v_add_f32 v131, v131, v152
    ds_write_b32 v42, v128 offset:0
    ds_write_b32 v42, v129 offset:1096
    ds_write_b32 v42, v130 offset:2192
    ds_write_b32 v42, v131 offset:3288
    ds_write_b32 v42, v139 offset:4388
    ds_write_b32 v42, v147 offset:5484
    ds_write_b32 v42, v155 offset:6580
    v_permlane16_swap_b32 v132, v140
    v_permlane16_swap_b32 v133, v141
    v_permlane16_swap_b32 v134, v142
    v_permlane16_swap_b32 v135, v143
    v_permlane16_swap_b32 v148, v156
    v_permlane16_swap_b32 v149, v157
    v_permlane16_swap_b32 v150, v158
    v_permlane16_swap_b32 v151, v159
    v_add_f32 v134, v134, v148
    v_add_f32 v135, v135, v149
    v_add_f32 v133, v133, v140
    v_add_f32 v143, v143, v150
    v_add_f32 v151, v151, v158
    v_add_f32 v134, v134, v141
    v_add_f32 v135, v135, v142
    v_add_f32 v143, v143, v157
    v_add_f32 v135, v135, v156
    ds_write_b32 v42, v132 offset:8
    ds_write_b32 v42, v133 offset:1104
    ds_write_b32 v42, v134 offset:2200
    ds_write_b32 v42, v135 offset:3296
    ds_write_b32 v43, v143 offset:4392
    ds_write_b32 v43, v151 offset:5488
    ds_write_b32 v43, v159 offset:6584
    v_permlane16_swap_b32 v224, v232
    v_permlane16_swap_b32 v225, v233
    v_permlane16_swap_b32 v226, v234
    v_permlane16_swap_b32 v227, v235
    v_permlane16_swap_b32 v240, v248
    v_permlane16_swap_b32 v241, v249
    v_permlane16_swap_b32 v242, v250
    v_permlane16_swap_b32 v243, v251
    v_add_f32 v226, v226, v240
    v_add_f32 v227, v227, v241
    v_add_f32 v225, v225, v232
    v_add_f32 v235, v235, v242
    v_add_f32 v243, v243, v250
    v_add_f32 v226, v226, v233
    v_add_f32 v227, v227, v234
    v_add_f32 v235, v235, v249
    v_add_f32 v227, v227, v248
    ds_write_b32 v42, v224 offset:11504
    ds_write_b32 v42, v225 offset:12600
    ds_write_b32 v42, v226 offset:13696
    ds_write_b32 v42, v227 offset:14792
    ds_write_b32 v42, v235 offset:8220
    ds_write_b32 v42, v243 offset:9316
    ds_write_b32 v42, v251 offset:10412
    v_permlane16_swap_b32 v228, v236
    v_permlane16_swap_b32 v229, v237
    v_permlane16_swap_b32 v230, v238
    v_permlane16_swap_b32 v231, v239
    v_permlane16_swap_b32 v244, v252
    v_permlane16_swap_b32 v245, v253
    v_permlane16_swap_b32 v246, v254
    v_permlane16_swap_b32 v247, v255
    v_add_f32 v230, v230, v244
    v_add_f32 v231, v231, v245
    v_add_f32 v229, v229, v236
    v_add_f32 v239, v239, v246
    v_add_f32 v247, v247, v254
    v_add_f32 v230, v230, v237
    v_add_f32 v231, v231, v238
    v_add_f32 v239, v239, v253
    v_add_f32 v231, v231, v252
    ds_write_b32 v42, v228 offset:11512
    ds_write_b32 v42, v229 offset:12608
    ds_write_b32 v42, v230 offset:13704
    ds_write_b32 v42, v231 offset:14800
    ds_write_b32 v43, v239 offset:8224
    ds_write_b32 v43, v247 offset:9320
    ds_write_b32 v43, v255 offset:10416
    s_branch L_he_42
L_h1_41:
    ds_read_b64_tr_b16 v[48:49], v40 offset:40
    ds_read_b64_tr_b16 v[50:51], v40 offset:8
    ds_read_b128 v[96:99], v41 offset:240
    ds_read_b64_tr_b16 v[52:53], v40 offset:1064
    ds_read_b64_tr_b16 v[54:55], v40 offset:1032
    ds_read_b64_tr_b16 v[56:57], v40 offset:2088
    ds_read_b64_tr_b16 v[58:59], v40 offset:2056
    ds_read_b128 v[100:103], v41 offset:496
    ds_read_b128 v[104:107], v41 offset:752
    ds_read_b128 v[108:111], v41 offset:2864
    ds_read_b128 v[112:115], v41 offset:3120
    ds_read_b128 v[116:119], v41 offset:3376
    s_waitcnt lgkmcnt(9)
    s_waitcnt lgkmcnt(7)
    v_mfma_f32_32x32x16_bf16 v[160:175], v[52:55], v[96:99], 0
    s_waitcnt lgkmcnt(5)
    v_mfma_f32_32x32x16_bf16 v[192:207], v[56:59], v[96:99], 0
    ds_read_b128 v[120:123], v41 offset:208
    ds_read_b64_tr_b16 v[64:65], v40 offset:168
    ds_read_b64_tr_b16 v[66:67], v40 offset:136
    s_waitcnt lgkmcnt(7)
    v_mfma_f32_32x32x16_bf16 v[160:175], v[48:51], v[100:103], v[160:175]
    v_mfma_f32_32x32x16_bf16 v[192:207], v[52:55], v[100:103], v[192:207]
    ds_read_b128 v[124:127], v41 offset:464
    ds_read_b64_tr_b16 v[68:69], v40 offset:1192
    ds_read_b64_tr_b16 v[70:71], v40 offset:1160
    s_waitcnt lgkmcnt(9)
    v_mfma_f32_32x32x16_bf16 v[192:207], v[48:51], v[104:107], v[192:207]
    ds_read_b128 v[96:99], v41 offset:720
    ds_read_b64_tr_b16 v[72:73], v40 offset:2216
    ds_read_b64_tr_b16 v[74:75], v40 offset:2184
    s_waitcnt lgkmcnt(11)
    v_mfma_f32_32x32x16_bf16 v[176:191], v[52:55], v[108:111], 0
    v_mfma_f32_32x32x16_bf16 v[208:223], v[56:59], v[108:111], 0
    ds_read_b128 v[100:103], v41 offset:2832
    s_waitcnt lgkmcnt(11)
    v_mfma_f32_32x32x16_bf16 v[176:191], v[48:51], v[112:115], v[176:191]
    v_mfma_f32_32x32x16_bf16 v[208:223], v[52:55], v[112:115], v[208:223]
    ds_read_b128 v[104:107], v41 offset:3088
    s_waitcnt lgkmcnt(11)
    v_mfma_f32_32x32x16_bf16 v[208:223], v[48:51], v[116:119], v[208:223]
    ds_read_b128 v[108:111], v41 offset:3344
    s_waitcnt lgkmcnt(11)
    s_waitcnt lgkmcnt(6)
    v_mfma_f32_32x32x16_bf16 v[160:175], v[68:71], v[120:123], v[160:175]
    s_waitcnt lgkmcnt(3)
    v_mfma_f32_32x32x16_bf16 v[192:207], v[72:75], v[120:123], v[192:207]
    ds_read_b128 v[112:115], v41 offset:176
    ds_read_b64_tr_b16 v[48:49], v40 offset:296
    ds_read_b64_tr_b16 v[50:51], v40 offset:264
    v_mfma_f32_32x32x16_bf16 v[160:175], v[64:67], v[124:127], v[160:175]
    v_mfma_f32_32x32x16_bf16 v[192:207], v[68:71], v[124:127], v[192:207]
    ds_read_b128 v[116:119], v41 offset:432
    ds_read_b64_tr_b16 v[52:53], v40 offset:1320
    ds_read_b64_tr_b16 v[54:55], v40 offset:1288
    v_mfma_f32_32x32x16_bf16 v[192:207], v[64:67], v[96:99], v[192:207]
    ds_read_b128 v[120:123], v41 offset:688
    ds_read_b64_tr_b16 v[56:57], v40 offset:2344
    ds_read_b64_tr_b16 v[58:59], v40 offset:2312
    s_waitcnt lgkmcnt(11)
    v_mfma_f32_32x32x16_bf16 v[176:191], v[68:71], v[100:103], v[176:191]
    v_mfma_f32_32x32x16_bf16 v[208:223], v[72:75], v[100:103], v[208:223]
    ds_read_b128 v[124:127], v41 offset:2800
    s_waitcnt lgkmcnt(11)
    v_mfma_f32_32x32x16_bf16 v[176:191], v[64:67], v[104:107], v[176:191]
    v_mfma_f32_32x32x16_bf16 v[208:223], v[68:71], v[104:107], v[208:223]
    ds_read_b128 v[96:99], v41 offset:3056
    s_waitcnt lgkmcnt(11)
    v_mfma_f32_32x32x16_bf16 v[208:223], v[64:67], v[108:111], v[208:223]
    ds_read_b128 v[100:103], v41 offset:3312
    s_waitcnt lgkmcnt(11)
    s_waitcnt lgkmcnt(6)
    v_mfma_f32_32x32x16_bf16 v[160:175], v[52:55], v[112:115], v[160:175]
    s_waitcnt lgkmcnt(3)
    v_mfma_f32_32x32x16_bf16 v[192:207], v[56:59], v[112:115], v[192:207]
    ds_read_b128 v[104:107], v41 offset:144
    ds_read_b64_tr_b16 v[64:65], v40 offset:424
    ds_read_b64_tr_b16 v[66:67], v40 offset:392
    v_mfma_f32_32x32x16_bf16 v[160:175], v[48:51], v[116:119], v[160:175]
    v_mfma_f32_32x32x16_bf16 v[192:207], v[52:55], v[116:119], v[192:207]
    ds_read_b128 v[108:111], v41 offset:400
    ds_read_b64_tr_b16 v[68:69], v40 offset:1448
    ds_read_b64_tr_b16 v[70:71], v40 offset:1416
    v_mfma_f32_32x32x16_bf16 v[192:207], v[48:51], v[120:123], v[192:207]
    ds_read_b128 v[112:115], v41 offset:656
    ds_read_b64_tr_b16 v[72:73], v40 offset:2472
    ds_read_b64_tr_b16 v[74:75], v40 offset:2440
    s_waitcnt lgkmcnt(11)
    v_mfma_f32_32x32x16_bf16 v[176:191], v[52:55], v[124:127], v[176:191]
    v_mfma_f32_32x32x16_bf16 v[208:223], v[56:59], v[124:127], v[208:223]
    ds_read_b128 v[116:119], v41 offset:2768
    s_waitcnt lgkmcnt(11)
    v_mfma_f32_32x32x16_bf16 v[176:191], v[48:51], v[96:99], v[176:191]
    v_mfma_f32_32x32x16_bf16 v[208:223], v[52:55], v[96:99], v[208:223]
    ds_read_b128 v[120:123], v41 offset:3024
    s_waitcnt lgkmcnt(11)
    v_mfma_f32_32x32x16_bf16 v[208:223], v[48:51], v[100:103], v[208:223]
    ds_read_b128 v[124:127], v41 offset:3280
    s_waitcnt lgkmcnt(11)
    s_waitcnt lgkmcnt(6)
    v_mfma_f32_32x32x16_bf16 v[160:175], v[68:71], v[104:107], v[160:175]
    s_waitcnt lgkmcnt(3)
    v_mfma_f32_32x32x16_bf16 v[192:207], v[72:75], v[104:107], v[192:207]
    ds_read_b128 v[96:99], v41 offset:112
    ds_read_b64_tr_b16 v[48:49], v40 offset:552
    ds_read_b64_tr_b16 v[50:51], v40 offset:520
    v_mfma_f32_32x32x16_bf16 v[160:175], v[64:67], v[108:111], v[160:175]
    v_mfma_f32_32x32x16_bf16 v[192:207], v[68:71], v[108:111], v[192:207]
    ds_read_b128 v[100:103], v41 offset:368
    ds_read_b64_tr_b16 v[52:53], v40 offset:1576
    ds_read_b64_tr_b16 v[54:55], v40 offset:1544
    v_mfma_f32_32x32x16_bf16 v[192:207], v[64:67], v[112:115], v[192:207]
    ds_read_b128 v[104:107], v41 offset:624
    ds_read_b64_tr_b16 v[56:57], v40 offset:2600
    ds_read_b64_tr_b16 v[58:59], v40 offset:2568
    s_waitcnt lgkmcnt(11)
    v_mfma_f32_32x32x16_bf16 v[176:191], v[68:71], v[116:119], v[176:191]
    v_mfma_f32_32x32x16_bf16 v[208:223], v[72:75], v[116:119], v[208:223]
    ds_read_b128 v[108:111], v41 offset:2736
    s_waitcnt lgkmcnt(11)
    v_mfma_f32_32x32x16_bf16 v[176:191], v[64:67], v[120:123], v[176:191]
    v_mfma_f32_32x32x16_bf16 v[208:223], v[68:71], v[120:123], v[208:223]
    ds_read_b128 v[112:115], v41 offset:2992
    s_waitcnt lgkmcnt(11)
    v_mfma_f32_32x32x16_bf16 v[208:223], v[64:67], v[124:127], v[208:223]
    ds_read_b128 v[116:119], v41 offset:3248
    s_waitcnt lgkmcnt(11)
    s_waitcnt lgkmcnt(6)
    v_mfma_f32_32x32x16_bf16 v[160:175], v[52:55], v[96:99], v[160:175]
    s_waitcnt lgkmcnt(3)
    v_mfma_f32_32x32x16_bf16 v[192:207], v[56:59], v[96:99], v[192:207]
    ds_read_b128 v[120:123], v41 offset:80
    ds_read_b64_tr_b16 v[64:65], v40 offset:680
    ds_read_b64_tr_b16 v[66:67], v40 offset:648
    v_mfma_f32_32x32x16_bf16 v[160:175], v[48:51], v[100:103], v[160:175]
    v_mfma_f32_32x32x16_bf16 v[192:207], v[52:55], v[100:103], v[192:207]
    ds_read_b128 v[124:127], v41 offset:336
    ds_read_b64_tr_b16 v[68:69], v40 offset:1704
    ds_read_b64_tr_b16 v[70:71], v40 offset:1672
    v_mfma_f32_32x32x16_bf16 v[192:207], v[48:51], v[104:107], v[192:207]
    ds_read_b128 v[96:99], v41 offset:592
    ds_read_b64_tr_b16 v[72:73], v40 offset:2728
    ds_read_b64_tr_b16 v[74:75], v40 offset:2696
    s_waitcnt lgkmcnt(11)
    v_mfma_f32_32x32x16_bf16 v[176:191], v[52:55], v[108:111], v[176:191]
    v_mfma_f32_32x32x16_bf16 v[208:223], v[56:59], v[108:111], v[208:223]
    ds_read_b128 v[100:103], v41 offset:2704
    s_waitcnt lgkmcnt(11)
    v_mfma_f32_32x32x16_bf16 v[176:191], v[48:51], v[112:115], v[176:191]
    v_mfma_f32_32x32x16_bf16 v[208:223], v[52:55], v[112:115], v[208:223]
    ds_read_b128 v[104:107], v41 offset:2960
    s_waitcnt lgkmcnt(11)
    v_mfma_f32_32x32x16_bf16 v[208:223], v[48:51], v[116:119], v[208:223]
    ds_read_b128 v[108:111], v41 offset:3216
    s_waitcnt lgkmcnt(11)
    s_waitcnt lgkmcnt(6)
    v_mfma_f32_32x32x16_bf16 v[160:175], v[68:71], v[120:123], v[160:175]
    s_waitcnt lgkmcnt(3)
    v_mfma_f32_32x32x16_bf16 v[192:207], v[72:75], v[120:123], v[192:207]
    ds_read_b128 v[112:115], v41 offset:48
    ds_read_b64_tr_b16 v[48:49], v40 offset:808
    ds_read_b64_tr_b16 v[50:51], v40 offset:776
    v_mfma_f32_32x32x16_bf16 v[160:175], v[64:67], v[124:127], v[160:175]
    v_mfma_f32_32x32x16_bf16 v[192:207], v[68:71], v[124:127], v[192:207]
    ds_read_b128 v[116:119], v41 offset:304
    ds_read_b64_tr_b16 v[52:53], v40 offset:1832
    ds_read_b64_tr_b16 v[54:55], v40 offset:1800
    v_mfma_f32_32x32x16_bf16 v[192:207], v[64:67], v[96:99], v[192:207]
    ds_read_b128 v[120:123], v41 offset:560
    ds_read_b64_tr_b16 v[56:57], v40 offset:2856
    ds_read_b64_tr_b16 v[58:59], v40 offset:2824
    s_waitcnt lgkmcnt(11)
    v_mfma_f32_32x32x16_bf16 v[176:191], v[68:71], v[100:103], v[176:191]
    v_mfma_f32_32x32x16_bf16 v[208:223], v[72:75], v[100:103], v[208:223]
    ds_read_b128 v[124:127], v41 offset:2672
    s_waitcnt lgkmcnt(11)
    v_mfma_f32_32x32x16_bf16 v[176:191], v[64:67], v[104:107], v[176:191]
    v_mfma_f32_32x32x16_bf16 v[208:223], v[68:71], v[104:107], v[208:223]
    ds_read_b128 v[96:99], v41 offset:2928
    s_waitcnt lgkmcnt(11)
    v_mfma_f32_32x32x16_bf16 v[208:223], v[64:67], v[108:111], v[208:223]
    ds_read_b128 v[100:103], v41 offset:3184
    s_waitcnt lgkmcnt(11)
    s_waitcnt lgkmcnt(6)
    v_mfma_f32_32x32x16_bf16 v[160:175], v[52:55], v[112:115], v[160:175]
    s_waitcnt lgkmcnt(3)
    v_mfma_f32_32x32x16_bf16 v[192:207], v[56:59], v[112:115], v[192:207]
    ds_read_b128 v[104:107], v41 offset:16
    ds_read_b64_tr_b16 v[64:65], v40 offset:936
    ds_read_b64_tr_b16 v[66:67], v40 offset:904
    v_mfma_f32_32x32x16_bf16 v[160:175], v[48:51], v[116:119], v[160:175]
    v_mfma_f32_32x32x16_bf16 v[192:207], v[52:55], v[116:119], v[192:207]
    ds_read_b128 v[108:111], v41 offset:272
    ds_read_b64_tr_b16 v[68:69], v40 offset:1960
    ds_read_b64_tr_b16 v[70:71], v40 offset:1928
    v_mfma_f32_32x32x16_bf16 v[192:207], v[48:51], v[120:123], v[192:207]
    ds_read_b128 v[112:115], v41 offset:528
    ds_read_b64_tr_b16 v[72:73], v40 offset:2984
    ds_read_b64_tr_b16 v[74:75], v40 offset:2952
    s_waitcnt lgkmcnt(11)
    v_mfma_f32_32x32x16_bf16 v[176:191], v[52:55], v[124:127], v[176:191]
    v_mfma_f32_32x32x16_bf16 v[208:223], v[56:59], v[124:127], v[208:223]
    ds_read_b128 v[116:119], v41 offset:2640
    s_waitcnt lgkmcnt(11)
    v_mfma_f32_32x32x16_bf16 v[176:191], v[48:51], v[96:99], v[176:191]
    v_mfma_f32_32x32x16_bf16 v[208:223], v[52:55], v[96:99], v[208:223]
    ds_read_b128 v[120:123], v41 offset:2896
    s_waitcnt lgkmcnt(11)
    v_mfma_f32_32x32x16_bf16 v[208:223], v[48:51], v[100:103], v[208:223]
    ds_read_b128 v[124:127], v41 offset:3152
    s_waitcnt lgkmcnt(11)
    s_waitcnt lgkmcnt(6)
    v_mfma_f32_32x32x16_bf16 v[160:175], v[68:71], v[104:107], v[160:175]
    s_waitcnt lgkmcnt(3)
    v_mfma_f32_32x32x16_bf16 v[192:207], v[72:75], v[104:107], v[192:207]
    v_mfma_f32_32x32x16_bf16 v[160:175], v[64:67], v[108:111], v[160:175]
    v_mfma_f32_32x32x16_bf16 v[192:207], v[68:71], v[108:111], v[192:207]
    v_mfma_f32_32x32x16_bf16 v[192:207], v[64:67], v[112:115], v[192:207]
    s_waitcnt lgkmcnt(2)
    v_mfma_f32_32x32x16_bf16 v[176:191], v[68:71], v[116:119], v[176:191]
    v_mfma_f32_32x32x16_bf16 v[208:223], v[72:75], v[116:119], v[208:223]
    s_waitcnt lgkmcnt(1)
    v_mfma_f32_32x32x16_bf16 v[176:191], v[64:67], v[120:123], v[176:191]
    v_mfma_f32_32x32x16_bf16 v[208:223], v[68:71], v[120:123], v[208:223]
    s_waitcnt lgkmcnt(0)
    v_mfma_f32_32x32x16_bf16 v[208:223], v[64:67], v[124:127], v[208:223]
    s_nop 1
    v_permlane16_swap_b32 v160, v168
    v_permlane16_swap_b32 v161, v169
    v_permlane16_swap_b32 v162, v170
    v_permlane16_swap_b32 v163, v171
    s_nop 2
    v_permlane16_swap_b32 v176, v184
    v_permlane16_swap_b32 v177, v185
    v_permlane16_swap_b32 v178, v186
    v_permlane16_swap_b32 v179, v187
    v_add_f32 v162, v162, v176
    v_add_f32 v163, v163, v177
    v_add_f32 v161, v161, v168
    v_add_f32 v171, v171, v178
    v_add_f32 v179, v179, v186
    v_add_f32 v162, v162, v169
    v_add_f32 v163, v163, v170
    v_add_f32 v171, v171, v185
    v_add_f32 v163, v163, v184
    ds_write_b32 v42, v160 offset:544
    ds_write_b32 v42, v161 offset:1640
    ds_write_b32 v42, v162 offset:2736
    ds_write_b32 v42, v163 offset:3832
    ds_write_b32 v42, v171 offset:4932
    ds_write_b32 v42, v179 offset:6028
    ds_write_b32 v42, v187 offset:7124
    v_permlane16_swap_b32 v164, v172
    v_permlane16_swap_b32 v165, v173
    v_permlane16_swap_b32 v166, v174
    v_permlane16_swap_b32 v167, v175
    v_permlane16_swap_b32 v180, v188
    v_permlane16_swap_b32 v181, v189
    v_permlane16_swap_b32 v182, v190
    v_permlane16_swap_b32 v183, v191
    v_add_f32 v166, v166, v180
    v_add_f32 v167, v167, v181
    v_add_f32 v165, v165, v172
    v_add_f32 v175, v175, v182
    v_add_f32 v183, v183, v190
    v_add_f32 v166, v166, v173
    v_add_f32 v167, v167, v174
    v_add_f32 v175, v175, v189
    v_add_f32 v167, v167, v188
    ds_write_b32 v42, v164 offset:552
    ds_write_b32 v42, v165 offset:1648
    ds_write_b32 v42, v166 offset:2744
    ds_write_b32 v42, v167 offset:3840
    ds_write_b32 v37, v175 offset:4936
    ds_write_b32 v37, v183 offset:6032
    ds_write_b32 v37, v191 offset:7128
    v_permlane16_swap_b32 v192, v200
    v_permlane16_swap_b32 v193, v201
    v_permlane16_swap_b32 v194, v202
    v_permlane16_swap_b32 v195, v203
    v_permlane16_swap_b32 v208, v216
    v_permlane16_swap_b32 v209, v217
    v_permlane16_swap_b32 v210, v218
    v_permlane16_swap_b32 v211, v219
    v_add_f32 v194, v194, v208
    v_add_f32 v195, v195, v209
    v_add_f32 v193, v193, v200
    v_add_f32 v203, v203, v210
    v_add_f32 v211, v211, v218
    v_add_f32 v194, v194, v201
    v_add_f32 v195, v195, v202
    v_add_f32 v203, v203, v217
    v_add_f32 v195, v195, v216
    ds_write_b32 v42, v192 offset:10960
    ds_write_b32 v42, v193 offset:12056
    ds_write_b32 v42, v194 offset:13152
    ds_write_b32 v42, v195 offset:14248
    ds_write_b32 v42, v203 offset:7676
    ds_write_b32 v42, v211 offset:8772
    ds_write_b32 v42, v219 offset:9868
    v_permlane16_swap_b32 v196, v204
    v_permlane16_swap_b32 v197, v205
    v_permlane16_swap_b32 v198, v206
    v_permlane16_swap_b32 v199, v207
    v_permlane16_swap_b32 v212, v220
    v_permlane16_swap_b32 v213, v221
    v_permlane16_swap_b32 v214, v222
    v_permlane16_swap_b32 v215, v223
    v_add_f32 v198, v198, v212
    v_add_f32 v199, v199, v213
    v_add_f32 v197, v197, v204
    v_add_f32 v207, v207, v214
    v_add_f32 v215, v215, v222
    v_add_f32 v198, v198, v205
    v_add_f32 v199, v199, v206
    v_add_f32 v207, v207, v221
    v_add_f32 v199, v199, v220
    ds_write_b32 v42, v196 offset:10968
    ds_write_b32 v42, v197 offset:12064
    ds_write_b32 v42, v198 offset:13160
    ds_write_b32 v42, v199 offset:14256
    ds_write_b32 v43, v207 offset:7680
    ds_write_b32 v43, v215 offset:8776
    ds_write_b32 v43, v223 offset:9872
L_he_42:
    v_mov_b32 v45, 1
    ds_write_b32 v38, v45
    s_setprio 0
    v_and_b32 v13, 255, v0
    s_waitcnt vmcnt(0)
    s_mov_b32 s12, 200000
L_aw_44:
    ds_read_b128 v[2:5], v39
    ds_read_b128 v[6:9], v39 offset:16
    s_waitcnt lgkmcnt(0)
    v_min3_u32 v2, v2, v3, v4
    v_min3_u32 v6, v6, v7, v8
    v_min_u32 v2, v2, v5
    v_min_u32 v6, v6, v9
    v_cmp_gt_u32 vcc, 1, v2
    v_cmp_gt_u32 s[6:7], 1, v6
    s_nop 0
    s_or_b64 vcc, vcc, s[6:7]
    s_nop 1
    s_cbranch_vccz L_awok_45
    s_sleep 1
    s_sub_u32 s12, s12, 1
    s_cbranch_scc0 L_aw_44
L_awok_45:
    v_lshrrev_b32 v2, 2, v13
    v_and_b32 v3, 3, v13
    v_lshlrev_b32 v2, 2, v2
    v_lshl_add_u32 v4, v2, 2, v3
    v_mul_u32_u24 v4, 4608, v4
    v_and_b32 v6, 1, v3
    v_lshrrev_b32 v9, 1, v3
    v_mul_u32_u24 v5, 1280, v6
    v_lshl_add_u32 v5, v2, 1, v5
    v_mul_u32_u24 v8, 2624, v9
    v_add_u32 v5, v5, v8
    v_lshrrev_b32 v8, 5, v2
    v_lshl_add_u32 v2, v8, 1, v2
    v_lshlrev_b32 v2, 2, v2
    v_mul_u32_u24 v8, 1096, v6
    v_add_u32 v2, v2, v8
    v_mul_u32_u24 v8, 2192, v9
    v_add_u32 v2, v2, v8
    v_add_u32 v2, 31488, v2
    v_add_u32 v8, 4384, v2
    v_cmp_eq_u32 vcc, 3, v3
    s_nop 1
    v_cndmask_b32 v8, v8, v2, vcc
    v_cndmask_b32 v9, 1.0, 0, vcc
    v_add_u32 v10, 72448, v2
    v_add_u32 v11, 72448, v8
    v_mov_b32 v12, v4
    v_mul_u32_u24 v14, 4596, v6
    v_sub_u32 v4, v4, v14
    s_mov_b32 s74, 0x55555555
    s_mov_b32 s75, 0x55555555
    s_mov_b32 s76, 0xaaaaaaaa
    s_mov_b32 s77, 0xaaaaaaaa
    s_lshl_b32 s14, s8, 2
    s_add_u32 s14, s14, 0
    ds_read_b64 v[128:129], v5 offset:256
    ds_read_b64 v[130:131], v5 offset:5504
    ds_read_b64 v[132:133], v5 offset:10752
    ds_read_b64 v[134:135], v5 offset:16000
    ds_read_b64 v[136:137], v5 offset:21248
    ds_read_b64 v[138:139], v5 offset:26496
    ds_read_b64 v[64:65], v2 offset:0
    ds_read_b64 v[66:67], v2 offset:8
    ds_read_b64 v[96:97], v8 offset:0
    ds_read_b64 v[98:99], v8 offset:8
    ds_read_b64 v[68:69], v2 offset:16048
    ds_read_b64 v[70:71], v2 offset:16056
    ds_read_b64 v[100:101], v8 offset:16048
    ds_read_b64 v[102:103], v8 offset:16056
    ds_read_b64 v[72:73], v2 offset:32096
    ds_read_b64 v[74:75], v2 offset:32104
    ds_read_b64 v[104:105], v8 offset:32096
    ds_read_b64 v[106:107], v8 offset:32104
    ds_read_b64 v[76:77], v2 offset:48144
    ds_read_b64 v[78:79], v2 offset:48152
    ds_read_b64 v[108:109], v8 offset:48144
    ds_read_b64 v[110:111], v8 offset:48152
    ds_read_b64 v[80:81], v10 offset:0
    ds_read_b64 v[82:83], v10 offset:8
    ds_read_b64 v[112:113], v11 offset:0
    ds_read_b64 v[114:115], v11 offset:8
    ds_read_b64 v[84:85], v10 offset:32096
    ds_read_b64 v[86:87], v10 offset:32104
    ds_read_b64 v[116:117], v11 offset:32096
    ds_read_b64 v[118:119], v11 offset:32104
    v_lshlrev_b32 v46, 16, v28
    v_and_b32 v47, 0xffff0000, v28
    v_lshlrev_b32 v48, 16, v29
    v_and_b32 v49, 0xffff0000, v29
    v_lshlrev_b32 v50, 16, v30
    v_and_b32 v51, 0xffff0000, v30
    s_waitcnt lgkmcnt(15)
    v_lshlrev_b32 v144, 16, v128
    v_mul_f32 v144, v144, v46
    v_lshlrev_b32 v145, 16, v130
    v_mul_f32 v145, v145, v47
    v_lshlrev_b32 v146, 16, v132
    v_mul_f32 v146, v146, v48
    v_lshlrev_b32 v147, 16, v134
    v_mul_f32 v147, v147, v49
    v_lshlrev_b32 v148, 16, v136
    v_mul_f32 v148, v148, v50
    v_lshlrev_b32 v149, 16, v138
    v_mul_f32 v149, v149, v51
    v_and_b32 v152, 0xffff0000, v128
    v_mul_f32 v152, v152, v46
    v_and_b32 v153, 0xffff0000, v130
    v_mul_f32 v153, v153, v47
    v_and_b32 v154, 0xffff0000, v132
    v_mul_f32 v154, v154, v48
    v_and_b32 v155, 0xffff0000, v134
    v_mul_f32 v155, v155, v49
    v_and_b32 v156, 0xffff0000, v136
    v_mul_f32 v156, v156, v50
    v_and_b32 v157, 0xffff0000, v138
    v_mul_f32 v157, v157, v51
    v_lshlrev_b32 v160, 16, v129
    v_mul_f32 v160, v160, v46
    v_lshlrev_b32 v161, 16, v131
    v_mul_f32 v161, v161, v47
    v_lshlrev_b32 v162, 16, v133
    v_mul_f32 v162, v162, v48
    v_lshlrev_b32 v163, 16, v135
    v_mul_f32 v163, v163, v49
    v_lshlrev_b32 v164, 16, v137
    v_mul_f32 v164, v164, v50
    v_lshlrev_b32 v165, 16, v139
    v_mul_f32 v165, v165, v51
    v_and_b32 v168, 0xffff0000, v129
    v_mul_f32 v168, v168, v46
    v_and_b32 v169, 0xffff0000, v131
    v_mul_f32 v169, v169, v47
    v_and_b32 v170, 0xffff0000, v133
    v_mul_f32 v170, v170, v48
    v_and_b32 v171, 0xffff0000, v135
    v_mul_f32 v171, v171, v49
    v_and_b32 v172, 0xffff0000, v137
    v_mul_f32 v172, v172, v50
    v_and_b32 v173, 0xffff0000, v139
    v_mul_f32 v173, v173, v51
    s_waitcnt lgkmcnt(0)
    v_fmac_f32 v64, v9, v96
    v_cvt_pk_bf16_f32 v144, v64, v144
    v_lshlrev_b32 v64, 16, v144
    v_and_b32 v144, 0xffff0000, v144
    v_add_f32 v144, v144, v64
    v_fmac_f32 v68, v9, v100
    v_cvt_pk_bf16_f32 v145, v68, v145
    v_lshlrev_b32 v68, 16, v145
    v_and_b32 v145, 0xffff0000, v145
    v_add_f32 v145, v145, v68
    v_fmac_f32 v72, v9, v104
    v_cvt_pk_bf16_f32 v146, v72, v146
    v_lshlrev_b32 v72, 16, v146
    v_and_b32 v146, 0xffff0000, v146
    v_add_f32 v146, v146, v72
    v_fmac_f32 v76, v9, v108
    v_cvt_pk_bf16_f32 v147, v76, v147
    v_lshlrev_b32 v76, 16, v147
    v_and_b32 v147, 0xffff0000, v147
    v_add_f32 v147, v147, v76
    v_fmac_f32 v80, v9, v112
    v_cvt_pk_bf16_f32 v148, v80, v148
    v_lshlrev_b32 v80, 16, v148
    v_and_b32 v148, 0xffff0000, v148
    v_add_f32 v148, v148, v80
    v_fmac_f32 v84, v9, v116
    v_cvt_pk_bf16_f32 v149, v84, v149
    v_lshlrev_b32 v84, 16, v149
    v_and_b32 v149, 0xffff0000, v149
    v_add_f32 v149, v149, v84
    v_cvt_pk_bf16_f32 v145, v144, v145
    v_lshlrev_b32 v144, 16, v145
    v_and_b32 v145, 0xffff0000, v145
    v_cvt_pk_bf16_f32 v147, v146, v147
    v_lshlrev_b32 v146, 16, v147
    v_and_b32 v147, 0xffff0000, v147
    v_cvt_pk_bf16_f32 v149, v148, v149
    v_lshlrev_b32 v148, 16, v149
    v_and_b32 v149, 0xffff0000, v149
    s_cmp_eq_u32 s10, 1
    s_cbranch_scc1 L_mid_46
    s_mov_b64 vcc, s[74:75]
    v_cndmask_b32_dpp v176, v147, v144, vcc quad_perm:[1,0,3,2] row_mask:0xf bank_mask:0xf
    v_cndmask_b32_dpp v177, v148, v145, vcc quad_perm:[1,0,3,2] row_mask:0xf bank_mask:0xf
    v_cndmask_b32_dpp v178, v149, v146, vcc quad_perm:[1,0,3,2] row_mask:0xf bank_mask:0xf
    s_add_u32 s15, s14, 0
    buffer_store_dwordx3 v[176:178], v4, s[64:67], s15 offen
    s_mov_b64 vcc, s[76:77]
    v_cndmask_b32_dpp v180, v144, v147, vcc quad_perm:[1,0,3,2] row_mask:0xf bank_mask:0xf
    v_cndmask_b32_dpp v181, v145, v148, vcc quad_perm:[1,0,3,2] row_mask:0xf bank_mask:0xf
    v_cndmask_b32_dpp v182, v146, v149, vcc quad_perm:[1,0,3,2] row_mask:0xf bank_mask:0xf
    s_add_u32 s15, s14, 4608
    buffer_store_dwordx3 v[180:182], v4, s[64:67], s15 offen
    s_branch L_ste_47
L_mid_46:
    s_add_u32 s15, s14, 0
    buffer_store_dwordx4 v[144:147], v12, s[64:67], s15 offen
L_ste_47:
    v_fmac_f32 v65, v9, v97
    v_cvt_pk_bf16_f32 v152, v65, v152
    v_lshlrev_b32 v65, 16, v152
    v_and_b32 v152, 0xffff0000, v152
    v_add_f32 v152, v152, v65
    v_fmac_f32 v69, v9, v101
    v_cvt_pk_bf16_f32 v153, v69, v153
    v_lshlrev_b32 v69, 16, v153
    v_and_b32 v153, 0xffff0000, v153
    v_add_f32 v153, v153, v69
    v_fmac_f32 v73, v9, v105
    v_cvt_pk_bf16_f32 v154, v73, v154
    v_lshlrev_b32 v73, 16, v154
    v_and_b32 v154, 0xffff0000, v154
    v_add_f32 v154, v154, v73
    v_fmac_f32 v77, v9, v109
    v_cvt_pk_bf16_f32 v155, v77, v155
    v_lshlrev_b32 v77, 16, v155
    v_and_b32 v155, 0xffff0000, v155
    v_add_f32 v155, v155, v77
    v_fmac_f32 v81, v9, v113
    v_cvt_pk_bf16_f32 v156, v81, v156
    v_lshlrev_b32 v81, 16, v156
    v_and_b32 v156, 0xffff0000, v156
    v_add_f32 v156, v156, v81
    v_fmac_f32 v85, v9, v117
    v_cvt_pk_bf16_f32 v157, v85, v157
    v_lshlrev_b32 v85, 16, v157
    v_and_b32 v157, 0xffff0000, v157
    v_add_f32 v157, v157, v85
    v_cvt_pk_bf16_f32 v153, v152, v153
    v_lshlrev_b32 v152, 16, v153
    v_and_b32 v153, 0xffff0000, v153
    v_cvt_pk_bf16_f32 v155, v154, v155
    v_lshlrev_b32 v154, 16, v155
    v_and_b32 v155, 0xffff0000, v155
    v_cvt_pk_bf16_f32 v157, v156, v157
    v_lshlrev_b32 v156, 16, v157
    v_and_b32 v157, 0xffff0000, v157
    s_cmp_eq_u32 s10, 1
    s_cbranch_scc1 L_mid_48
    s_mov_b64 vcc, s[74:75]
    v_cndmask_b32_dpp v184, v155, v152, vcc quad_perm:[1,0,3,2] row_mask:0xf bank_mask:0xf
    v_cndmask_b32_dpp v185, v156, v153, vcc quad_perm:[1,0,3,2] row_mask:0xf bank_mask:0xf
    v_cndmask_b32_dpp v186, v157, v154, vcc quad_perm:[1,0,3,2] row_mask:0xf bank_mask:0xf
    s_add_u32 s15, s14, 18432
    buffer_store_dwordx3 v[184:186], v4, s[64:67], s15 offen
    s_mov_b64 vcc, s[76:77]
    v_cndmask_b32_dpp v188, v152, v155, vcc quad_perm:[1,0,3,2] row_mask:0xf bank_mask:0xf
    v_cndmask_b32_dpp v189, v153, v156, vcc quad_perm:[1,0,3,2] row_mask:0xf bank_mask:0xf
    v_cndmask_b32_dpp v190, v154, v157, vcc quad_perm:[1,0,3,2] row_mask:0xf bank_mask:0xf
    s_add_u32 s15, s14, 23040
    buffer_store_dwordx3 v[188:190], v4, s[64:67], s15 offen
    s_branch L_ste_49
L_mid_48:
    s_add_u32 s15, s14, 18432
    buffer_store_dwordx4 v[152:155], v12, s[64:67], s15 offen
L_ste_49:
    v_fmac_f32 v66, v9, v98
    v_cvt_pk_bf16_f32 v160, v66, v160
    v_lshlrev_b32 v66, 16, v160
    v_and_b32 v160, 0xffff0000, v160
    v_add_f32 v160, v160, v66
    v_fmac_f32 v70, v9, v102
    v_cvt_pk_bf16_f32 v161, v70, v161
    v_lshlrev_b32 v70, 16, v161
    v_and_b32 v161, 0xffff0000, v161
    v_add_f32 v161, v161, v70
    v_fmac_f32 v74, v9, v106
    v_cvt_pk_bf16_f32 v162, v74, v162
    v_lshlrev_b32 v74, 16, v162
    v_and_b32 v162, 0xffff0000, v162
    v_add_f32 v162, v162, v74
    v_fmac_f32 v78, v9, v110
    v_cvt_pk_bf16_f32 v163, v78, v163
    v_lshlrev_b32 v78, 16, v163
    v_and_b32 v163, 0xffff0000, v163
    v_add_f32 v163, v163, v78
    v_fmac_f32 v82, v9, v114
    v_cvt_pk_bf16_f32 v164, v82, v164
    v_lshlrev_b32 v82, 16, v164
    v_and_b32 v164, 0xffff0000, v164
    v_add_f32 v164, v164, v82
    v_fmac_f32 v86, v9, v118
    v_cvt_pk_bf16_f32 v165, v86, v165
    v_lshlrev_b32 v86, 16, v165
    v_and_b32 v165, 0xffff0000, v165
    v_add_f32 v165, v165, v86
    v_cvt_pk_bf16_f32 v161, v160, v161
    v_lshlrev_b32 v160, 16, v161
    v_and_b32 v161, 0xffff0000, v161
    v_cvt_pk_bf16_f32 v163, v162, v163
    v_lshlrev_b32 v162, 16, v163
    v_and_b32 v163, 0xffff0000, v163
    v_cvt_pk_bf16_f32 v165, v164, v165
    v_lshlrev_b32 v164, 16, v165
    v_and_b32 v165, 0xffff0000, v165
    s_cmp_eq_u32 s10, 1
    s_cbranch_scc1 L_mid_50
    s_mov_b64 vcc, s[74:75]
    v_cndmask_b32_dpp v192, v163, v160, vcc quad_perm:[1,0,3,2] row_mask:0xf bank_mask:0xf
    v_cndmask_b32_dpp v193, v164, v161, vcc quad_perm:[1,0,3,2] row_mask:0xf bank_mask:0xf
    v_cndmask_b32_dpp v194, v165, v162, vcc quad_perm:[1,0,3,2] row_mask:0xf bank_mask:0xf
    s_add_u32 s15, s14, 36864
    buffer_store_dwordx3 v[192:194], v4, s[64:67], s15 offen
    s_mov_b64 vcc, s[76:77]
    v_cndmask_b32_dpp v196, v160, v163, vcc quad_perm:[1,0,3,2] row_mask:0xf bank_mask:0xf
    v_cndmask_b32_dpp v197, v161, v164, vcc quad_perm:[1,0,3,2] row_mask:0xf bank_mask:0xf
    v_cndmask_b32_dpp v198, v162, v165, vcc quad_perm:[1,0,3,2] row_mask:0xf bank_mask:0xf
    s_add_u32 s15, s14, 41472
    buffer_store_dwordx3 v[196:198], v4, s[64:67], s15 offen
    s_branch L_ste_51
L_mid_50:
    s_add_u32 s15, s14, 36864
    buffer_store_dwordx4 v[160:163], v12, s[64:67], s15 offen
L_ste_51:
    v_fmac_f32 v67, v9, v99
    v_cvt_pk_bf16_f32 v168, v67, v168
    v_lshlrev_b32 v67, 16, v168
    v_and_b32 v168, 0xffff0000, v168
    v_add_f32 v168, v168, v67
    v_fmac_f32 v71, v9, v103
    v_cvt_pk_bf16_f32 v169, v71, v169
    v_lshlrev_b32 v71, 16, v169
    v_and_b32 v169, 0xffff0000, v169
    v_add_f32 v169, v169, v71
    v_fmac_f32 v75, v9, v107
    v_cvt_pk_bf16_f32 v170, v75, v170
    v_lshlrev_b32 v75, 16, v170
    v_and_b32 v170, 0xffff0000, v170
    v_add_f32 v170, v170, v75
    v_fmac_f32 v79, v9, v111
    v_cvt_pk_bf16_f32 v171, v79, v171
    v_lshlrev_b32 v79, 16, v171
    v_and_b32 v171, 0xffff0000, v171
    v_add_f32 v171, v171, v79
    v_fmac_f32 v83, v9, v115
    v_cvt_pk_bf16_f32 v172, v83, v172
    v_lshlrev_b32 v83, 16, v172
    v_and_b32 v172, 0xffff0000, v172
    v_add_f32 v172, v172, v83
    v_fmac_f32 v87, v9, v119
    v_cvt_pk_bf16_f32 v173, v87, v173
    v_lshlrev_b32 v87, 16, v173
    v_and_b32 v173, 0xffff0000, v173
    v_add_f32 v173, v173, v87
    v_cvt_pk_bf16_f32 v169, v168, v169
    v_lshlrev_b32 v168, 16, v169
    v_and_b32 v169, 0xffff0000, v169
    v_cvt_pk_bf16_f32 v171, v170, v171
    v_lshlrev_b32 v170, 16, v171
    v_and_b32 v171, 0xffff0000, v171
    v_cvt_pk_bf16_f32 v173, v172, v173
    v_lshlrev_b32 v172, 16, v173
    v_and_b32 v173, 0xffff0000, v173
    s_cmp_eq_u32 s10, 1
    s_cbranch_scc1 L_mid_52
    s_mov_b64 vcc, s[74:75]
    v_cndmask_b32_dpp v200, v171, v168, vcc quad_perm:[1,0,3,2] row_mask:0xf bank_mask:0xf
    v_cndmask_b32_dpp v201, v172, v169, vcc quad_perm:[1,0,3,2] row_mask:0xf bank_mask:0xf
    v_cndmask_b32_dpp v202, v173, v170, vcc quad_perm:[1,0,3,2] row_mask:0xf bank_mask:0xf
    s_add_u32 s15, s14, 55296
    buffer_store_dwordx3 v[200:202], v4, s[64:67], s15 offen
    s_mov_b64 vcc, s[76:77]
    v_cndmask_b32_dpp v204, v168, v171, vcc quad_perm:[1,0,3,2] row_mask:0xf bank_mask:0xf
    v_cndmask_b32_dpp v205, v169, v172, vcc quad_perm:[1,0,3,2] row_mask:0xf bank_mask:0xf
    v_cndmask_b32_dpp v206, v170, v173, vcc quad_perm:[1,0,3,2] row_mask:0xf bank_mask:0xf
    s_add_u32 s15, s14, 59904
    buffer_store_dwordx3 v[204:206], v4, s[64:67], s15 offen
    s_branch L_ste_53
L_mid_52:
    s_add_u32 s15, s14, 55296
    buffer_store_dwordx4 v[168:171], v12, s[64:67], s15 offen
L_ste_53:
L_ce_43:
    s_waitcnt lgkmcnt(0)
    s_barrier
    v_lshrrev_b32 v2, 2, v0
    v_and_b32 v3, 3, v0
    v_lshlrev_b32 v2, 1, v2
    v_lshl_add_u32 v4, v2, 2, v3
    v_mul_u32_u24 v4, 4608, v4
    v_and_b32 v6, 1, v3
    v_lshrrev_b32 v9, 1, v3
    v_mul_u32_u24 v5, 1280, v6
    v_lshl_add_u32 v5, v2, 1, v5
    v_mul_u32_u24 v8, 2624, v9
    v_add_u32 v5, v5, v8
    v_lshrrev_b32 v8, 5, v2
    v_lshl_add_u32 v2, v8, 1, v2
    v_lshlrev_b32 v2, 2, v2
    v_mul_u32_u24 v8, 1096, v6
    v_add_u32 v2, v2, v8
    v_mul_u32_u24 v8, 2192, v9
    v_add_u32 v2, v2, v8
    v_add_u32 v2, 42448, v2
    v_add_u32 v8, 4294964008, v2
    v_cmp_eq_u32 vcc, 3, v3
    s_nop 1
    v_cndmask_b32 v8, v8, v2, vcc
    v_cndmask_b32 v9, 1.0, 0, vcc
    v_add_u32 v10, 72448, v2
    v_add_u32 v11, 72448, v8
    v_mov_b32 v12, v4
    v_mul_u32_u24 v14, 4596, v6
    v_sub_u32 v4, v4, v14
    s_mov_b32 s74, 0x55555555
    s_mov_b32 s75, 0x55555555
    s_mov_b32 s76, 0xaaaaaaaa
    s_mov_b32 s77, 0xaaaaaaaa
    s_lshl_b32 s14, s8, 2
    s_add_u32 s14, s14, 4718592
    ds_read_b32 v128, v5 offset:768
    ds_read_b32 v130, v5 offset:6016
    ds_read_b32 v132, v5 offset:11264
    ds_read_b32 v134, v5 offset:16512
    ds_read_b32 v136, v5 offset:21760
    ds_read_b32 v138, v5 offset:27008
    ds_read_b64 v[64:65], v2 offset:0
    ds_read_b64 v[96:97], v8 offset:0
    ds_read_b64 v[68:69], v2 offset:16048
    ds_read_b64 v[100:101], v8 offset:16048
    ds_read_b64 v[72:73], v2 offset:32096
    ds_read_b64 v[104:105], v8 offset:32096
    ds_read_b64 v[76:77], v2 offset:48144
    ds_read_b64 v[108:109], v8 offset:48144
    ds_read_b64 v[80:81], v10 offset:0
    ds_read_b64 v[112:113], v11 offset:0
    ds_read_b64 v[84:85], v10 offset:32096
    ds_read_b64 v[116:117], v11 offset:32096
    v_lshlrev_b32 v46, 16, v28
    v_and_b32 v47, 0xffff0000, v28
    v_lshlrev_b32 v48, 16, v29
    v_and_b32 v49, 0xffff0000, v29
    v_lshlrev_b32 v50, 16, v30
    v_and_b32 v51, 0xffff0000, v30
    s_waitcnt lgkmcnt(12)
    v_lshlrev_b32 v144, 16, v128
    v_mul_f32 v144, v144, v46
    v_lshlrev_b32 v145, 16, v130
    v_mul_f32 v145, v145, v47
    v_lshlrev_b32 v146, 16, v132
    v_mul_f32 v146, v146, v48
    v_lshlrev_b32 v147, 16, v134
    v_mul_f32 v147, v147, v49
    v_lshlrev_b32 v148, 16, v136
    v_mul_f32 v148, v148, v50
    v_lshlrev_b32 v149, 16, v138
    v_mul_f32 v149, v149, v51
    v_and_b32 v152, 0xffff0000, v128
    v_mul_f32 v152, v152, v46
    v_and_b32 v153, 0xffff0000, v130
    v_mul_f32 v153, v153, v47
    v_and_b32 v154, 0xffff0000, v132
    v_mul_f32 v154, v154, v48
    v_and_b32 v155, 0xffff0000, v134
    v_mul_f32 v155, v155, v49
    v_and_b32 v156, 0xffff0000, v136
    v_mul_f32 v156, v156, v50
    v_and_b32 v157, 0xffff0000, v138
    v_mul_f32 v157, v157, v51
    s_waitcnt lgkmcnt(0)
    v_fmac_f32 v64, v9, v96
    v_cvt_pk_bf16_f32 v144, v64, v144
    v_lshlrev_b32 v64, 16, v144
    v_and_b32 v144, 0xffff0000, v144
    v_add_f32 v144, v144, v64
    v_fmac_f32 v68, v9, v100
    v_cvt_pk_bf16_f32 v145, v68, v145
    v_lshlrev_b32 v68, 16, v145
    v_and_b32 v145, 0xffff0000, v145
    v_add_f32 v145, v145, v68
    v_fmac_f32 v72, v9, v104
    v_cvt_pk_bf16_f32 v146, v72, v146
    v_lshlrev_b32 v72, 16, v146
    v_and_b32 v146, 0xffff0000, v146
    v_add_f32 v146, v146, v72
    v_fmac_f32 v76, v9, v108
    v_cvt_pk_bf16_f32 v147, v76, v147
    v_lshlrev_b32 v76, 16, v147
    v_and_b32 v147, 0xffff0000, v147
    v_add_f32 v147, v147, v76
    v_fmac_f32 v80, v9, v112
    v_cvt_pk_bf16_f32 v148, v80, v148
    v_lshlrev_b32 v80, 16, v148
    v_and_b32 v148, 0xffff0000, v148
    v_add_f32 v148, v148, v80
    v_fmac_f32 v84, v9, v116
    v_cvt_pk_bf16_f32 v149, v84, v149
    v_lshlrev_b32 v84, 16, v149
    v_and_b32 v149, 0xffff0000, v149
    v_add_f32 v149, v149, v84
    v_cvt_pk_bf16_f32 v145, v144, v145
    v_lshlrev_b32 v144, 16, v145
    v_and_b32 v145, 0xffff0000, v145
    v_cvt_pk_bf16_f32 v147, v146, v147
    v_lshlrev_b32 v146, 16, v147
    v_and_b32 v147, 0xffff0000, v147
    v_cvt_pk_bf16_f32 v149, v148, v149
    v_lshlrev_b32 v148, 16, v149
    v_and_b32 v149, 0xffff0000, v149
    s_cmp_eq_u32 s10, 1
    s_cbranch_scc1 L_mid_54
    s_mov_b64 vcc, s[74:75]
    v_cndmask_b32_dpp v176, v147, v144, vcc quad_perm:[1,0,3,2] row_mask:0xf bank_mask:0xf
    v_cndmask_b32_dpp v177, v148, v145, vcc quad_perm:[1,0,3,2] row_mask:0xf bank_mask:0xf
    v_cndmask_b32_dpp v178, v149, v146, vcc quad_perm:[1,0,3,2] row_mask:0xf bank_mask:0xf
    s_add_u32 s15, s14, 0
    buffer_store_dwordx3 v[176:178], v4, s[64:67], s15 offen
    s_mov_b64 vcc, s[76:77]
    v_cndmask_b32_dpp v180, v144, v147, vcc quad_perm:[1,0,3,2] row_mask:0xf bank_mask:0xf
    v_cndmask_b32_dpp v181, v145, v148, vcc quad_perm:[1,0,3,2] row_mask:0xf bank_mask:0xf
    v_cndmask_b32_dpp v182, v146, v149, vcc quad_perm:[1,0,3,2] row_mask:0xf bank_mask:0xf
    s_add_u32 s15, s14, 4608
    buffer_store_dwordx3 v[180:182], v4, s[64:67], s15 offen
    s_branch L_ste_55
L_mid_54:
    s_add_u32 s15, s14, 0
    buffer_store_dwordx4 v[144:147], v12, s[64:67], s15 offen
L_ste_55:
    v_fmac_f32 v65, v9, v97
    v_cvt_pk_bf16_f32 v152, v65, v152
    v_lshlrev_b32 v65, 16, v152
    v_and_b32 v152, 0xffff0000, v152
    v_add_f32 v152, v152, v65
    v_fmac_f32 v69, v9, v101
    v_cvt_pk_bf16_f32 v153, v69, v153
    v_lshlrev_b32 v69, 16, v153
    v_and_b32 v153, 0xffff0000, v153
    v_add_f32 v153, v153, v69
    v_fmac_f32 v73, v9, v105
    v_cvt_pk_bf16_f32 v154, v73, v154
    v_lshlrev_b32 v73, 16, v154
    v_and_b32 v154, 0xffff0000, v154
    v_add_f32 v154, v154, v73
    v_fmac_f32 v77, v9, v109
    v_cvt_pk_bf16_f32 v155, v77, v155
    v_lshlrev_b32 v77, 16, v155
    v_and_b32 v155, 0xffff0000, v155
    v_add_f32 v155, v155, v77
    v_fmac_f32 v81, v9, v113
    v_cvt_pk_bf16_f32 v156, v81, v156
    v_lshlrev_b32 v81, 16, v156
    v_and_b32 v156, 0xffff0000, v156
    v_add_f32 v156, v156, v81
    v_fmac_f32 v85, v9, v117
    v_cvt_pk_bf16_f32 v157, v85, v157
    v_lshlrev_b32 v85, 16, v157
    v_and_b32 v157, 0xffff0000, v157
    v_add_f32 v157, v157, v85
    v_cvt_pk_bf16_f32 v153, v152, v153
    v_lshlrev_b32 v152, 16, v153
    v_and_b32 v153, 0xffff0000, v153
    v_cvt_pk_bf16_f32 v155, v154, v155
    v_lshlrev_b32 v154, 16, v155
    v_and_b32 v155, 0xffff0000, v155
    v_cvt_pk_bf16_f32 v157, v156, v157
    v_lshlrev_b32 v156, 16, v157
    v_and_b32 v157, 0xffff0000, v157
    s_cmp_eq_u32 s10, 1
    s_cbranch_scc1 L_mid_56
    s_mov_b64 vcc, s[74:75]
    v_cndmask_b32_dpp v184, v155, v152, vcc quad_perm:[1,0,3,2] row_mask:0xf bank_mask:0xf
    v_cndmask_b32_dpp v185, v156, v153, vcc quad_perm:[1,0,3,2] row_mask:0xf bank_mask:0xf
    v_cndmask_b32_dpp v186, v157, v154, vcc quad_perm:[1,0,3,2] row_mask:0xf bank_mask:0xf
    s_add_u32 s15, s14, 18432
    buffer_store_dwordx3 v[184:186], v4, s[64:67], s15 offen
    s_mov_b64 vcc, s[76:77]
    v_cndmask_b32_dpp v188, v152, v155, vcc quad_perm:[1,0,3,2] row_mask:0xf bank_mask:0xf
    v_cndmask_b32_dpp v189, v153, v156, vcc quad_perm:[1,0,3,2] row_mask:0xf bank_mask:0xf
    v_cndmask_b32_dpp v190, v154, v157, vcc quad_perm:[1,0,3,2] row_mask:0xf bank_mask:0xf
    s_add_u32 s15, s14, 23040
    buffer_store_dwordx3 v[188:190], v4, s[64:67], s15 offen
    s_branch L_ste_57
L_mid_56:
    s_add_u32 s15, s14, 18432
    buffer_store_dwordx4 v[152:155], v12, s[64:67], s15 offen
L_ste_57:
L_exit:
    s_endpgm
L_codeend:
.if (L_codeend - concat_heads__ssm_conv_s4__ssm_conv_s5__prompt_kernel) > 33792
.error "code larger than prefetch window"
.endif
.fill (33792 - (L_codeend - concat_heads__ssm_conv_s4__ssm_conv_s5__prompt_kernel)) / 4, 4, 0xbf810000
.section .rodata,"a"
.p2align 6
.amdhsa_kernel concat_heads__ssm_conv_s4__ssm_conv_s5__prompt_kernel
  .amdhsa_next_free_vgpr 256
  .amdhsa_next_free_sgpr 102
  .amdhsa_accum_offset 256
  .amdhsa_group_segment_fixed_size 0
  .amdhsa_kernarg_size 168
  .amdhsa_user_sgpr_count 2
  .amdhsa_user_sgpr_kernarg_segment_ptr 1
  .amdhsa_system_sgpr_workgroup_id_x 1
.end_amdhsa_kernel
```
